```python
import torch

def _softmax(x, axis=-1):
    return torch.softmax(x, dim=axis)
def _gelu(x):
    return torch.nn.functional.gelu(x, approximate="tanh")
def _silu(x):
    return torch.nn.functional.silu(x)
def _sigmoid(x):
    return torch.sigmoid(x)
def _layernorm(x, axis=-1, eps=1e-5):
    m = x.mean(dim=axis, keepdim=True)
    v = x.var(dim=axis, keepdim=True, unbiased=False)
    return (x - m) / torch.sqrt(v + eps)
def _scatter_add(tgt, idx, src, axis=0):
    return tgt.clone().index_add_(axis, idx, src)
def _segment_sum(src, seg, n):
    out = torch.zeros((n,) + src.shape[1:], dtype=src.dtype)
    return out.index_add_(0, seg, src)
def _pad(x, pw):
    flat = tuple(v for pair in reversed(pw) for v in pair)
    return torch.nn.functional.pad(x, flat)

kernel_name = 'parallel_sum__gqa_block_cached__glu_gated_bilinear__decode'

def setup_inputs():

    _w = (lambda a: (lambda t: t.to(torch.bfloat16) if t.is_floating_point() else t)(torch.as_tensor(a)))
    def _A_setup():
        B, Sq, D = 8, 1, 512
        Hq, Hkv, Sk, Dh = 32, 8, 8192, 128
        assert Hq % Hkv == 0, (Hq, Hkv)
        return {
            "x": _w((lambda *s: torch.randn(*s, dtype=torch.bfloat16) * 0.05)(B, Sq, D)),
            "k_cache": _w((lambda *s: torch.randn(*s, dtype=torch.bfloat16) * 1.6)(B, Hkv, Sk, Dh)),
            "v_cache": _w((lambda *s: torch.randn(*s, dtype=torch.bfloat16) * 0.8)(B, Hkv, Sk, Dh)),
            "wq": _w((lambda *s: torch.randn(*s, dtype=torch.bfloat16) * 1.6)(D, Hq * Dh) * (D ** -0.5)),
            "wo": _w((lambda *s: torch.randn(*s, dtype=torch.bfloat16) * 0.8)(Hq * Dh, D) * ((Hq * Dh) ** -0.5)),
        }
    _A_in = _A_setup()

    def _B_setup():
        B, S, D, F = 8, 1, 512, 1792
        return {
            "x": _w((lambda *s: torch.randn(*s, dtype=torch.bfloat16) * 0.05)(B, S, D)),
            "w_gate": _w((lambda *s: torch.randn(*s, dtype=torch.bfloat16) * 0.4)(D, F) * (D ** -0.5)),
            "w_up": _w((lambda *s: torch.randn(*s, dtype=torch.bfloat16) * 0.4)(D, F) * (D ** -0.5)),
            "w_down": _w((lambda *s: torch.randn(*s, dtype=torch.bfloat16) * 0.4)(F, D) * (F ** -0.5)),
        }
    _B_in = _B_setup()

    return {
        "A_x": _A_in["x"],
        "A_k_cache": _A_in["k_cache"],
        "A_v_cache": _A_in["v_cache"],
        "A_wq": _A_in["wq"],
        "A_wo": _A_in["wo"],
        "B_x": _B_in["x"],
        "B_w_gate": _B_in["w_gate"],
        "B_w_up": _B_in["w_up"],
        "B_w_down": _B_in["w_down"],
    }

def reference(A_x, A_k_cache, A_v_cache, A_wq, A_wo, B_x, B_w_gate, B_w_up, B_w_down):
    def _A_ref(x, k_cache, v_cache, wq, wo):
        B, Sq, D = x.shape
        Hq, Dh = 32, 128
        Hkv = k_cache.shape[1]
        rep = Hq // Hkv
        q = (lambda x, *d: x.permute(*d))((x @ wq).reshape(B, Sq, Hq, Dh), 0, 2, 1, 3)
        k = (lambda x, n, axis: torch.repeat_interleave(x, n, dim=axis))(k_cache, rep, axis=1)
        v = (lambda x, n, axis: torch.repeat_interleave(x, n, dim=axis))(v_cache, rep, axis=1)
        scores = torch.einsum("bhqd,bhkd->bhqk", q, k) * (Dh ** -0.5)
        p = _softmax(scores, axis=-1)
        o = torch.einsum("bhqk,bhkd->bhqd", p, v)
        return (lambda x, *d: x.permute(*d))(o, 0, 2, 1, 3).reshape(B, Sq, Hq * Dh) @ wo

    def _B_ref(x, w_gate, w_up, w_down):
        g = torch.einsum("bsd,df->bsf", x, w_gate)
        u = torch.einsum("bsd,df->bsf", x, w_up)
        h = g * u
        return torch.einsum("bsf,fd->bsd", h, w_down)

    x = A_x
    xn = _layernorm(x, axis=-1)
    return x + _A_ref(xn, A_k_cache, A_v_cache, A_wq, A_wo) + _B_ref(xn, B_w_gate, B_w_up, B_w_down)
```

```asm
; @launch grid=(256,1,1) block=(512,1,1) lds=162048
.amdgcn_target "amdgcn-amd-amdhsa--gfx950"
.text
.globl parallel_sum__gqa_block_cached__glu_gated_bilinear__decode_kernel
.p2align 8
.type parallel_sum__gqa_block_cached__glu_gated_bilinear__decode_kernel,@function
parallel_sum__gqa_block_cached__glu_gated_bilinear__decode_kernel:
    s_cmp_ge_u32 s2, 256
    s_cbranch_scc1 L_end
    s_load_dwordx16 s[4:19], s[0:1], 0
    s_load_dwordx8 s[20:27], s[0:1], 64
    v_lshrrev_b32 v1, 6, v0
    v_and_b32 v0, 63, v0
    s_lshr_b32 s29, s2, 3
    s_and_b32 s29, s29, 7
    v_readfirstlane_b32 s28, v1
    s_and_b32 s3, s2, 7
    s_lshl_b32 s30, s3, 2
    s_lshr_b32 s33, s2, 6
    s_or_b32 s30, s30, s33
    s_lshl_b32 s31, s29, 5
    s_or_b32 s31, s31, s30
    v_and_b32 v1, 15, v0
    v_lshrrev_b32 v2, 4, v0
    s_lshl_b32 s73, s3, 3
    s_or_b32 s73, s73, s29
    s_lshl_b32 s73, s73, 2
    s_or_b32 s73, s73, s33
    s_mov_b32 s35, 1073741824
    s_and_b32 s69, s73, 3
    s_lshr_b32 s70, s73, 2
    s_lshl_b32 s34, s3, 2
    s_sub_u32 s73, s73, s34
    s_cmp_eq_u32 s29, 7
    s_cselect_b32 s73, 224, s73
    s_lshr_b32 s71, s73, 3
    s_mul_i32 s72, s30, 7
    s_lshr_b32 s72, s72, 1
    v_mov_b32 v16, 0
    v_mov_b32 v17, 0
    v_mov_b32 v18, 0
    v_mov_b32 v19, 0
    v_mov_b32 v5, 161792
    ds_write_b128 v5, v[16:19]
    ds_write_b128 v5, v[16:19] offset:16
    ds_write_b128 v5, v[16:19] offset:32
    s_cmp_ge_u32 s28, 4
    s_cbranch_scc1 L_stream
    s_setprio 2
    v_lshlrev_b32 v3, 5, v0
    s_lshl_b32 s52, s28, 11
    s_waitcnt lgkmcnt(0)
    s_mov_b32 s36, s4
    s_and_b32 s37, s5, 0xffff
    s_mov_b32 s38, 8192
    s_mov_b32 s39, 0x20000
    buffer_load_dwordx4 v[8:11], v3, s[36:39], s52 offen
    buffer_load_dwordx4 v[12:15], v3, s[36:39], s52 offen offset:16
    s_load_dword s32, s[26:27], 0
    s_mov_b32 s44, s26
    s_and_b32 s45, s27, 0xffff
    s_mov_b32 s46, 0x220000
    s_mov_b32 s47, 0x20000
    s_mov_b32 s40, s22
    s_and_b32 s41, s23, 0xffff
    s_mov_b32 s42, 8192
    s_mov_b32 s43, 0x20000
    s_barrier
    v_lshrrev_b32 v6, 2, v1
    v_lshl_add_u32 v6, v2, 3, v6
    v_and_b32 v7, 3, v1
    v_and_b32 v50, 7, v1
    v_mov_b32 v59, s35
    v_lshrrev_b32 v55, 5, v0
    v_and_b32 v56, 31, v0
    v_mul_u32_u24 v48, 1056, v55
    v_lshl_add_u32 v48, v56, 5, v48
    s_mul_i32 s33, s28, 2112
    s_add_u32 s33, s33, 139264
    v_add_u32 v48, s33, v48
    v_lshlrev_b32 v49, 7, v6
    v_lshl_add_u32 v49, v7, 3, v49
    s_lshl_b32 s33, s28, 5
    s_add_u32 s33, s33, 98304
    v_add_u32 v49, s33, v49
    v_mul_u32_u24 v52, 1056, v50
    v_lshl_add_u32 v52, v2, 4, v52
    s_lshl_b32 s33, s69, 8
    s_add_u32 s33, s33, 139264
    v_add_u32 v52, s33, v52
    v_lshlrev_b32 v51, 6, v1
    v_lshl_add_u32 v51, v2, 4, v51
    v_cmp_gt_u32 vcc, 8, v1
    s_lshl_b32 s56, s70, 2
    s_add_u32 s56, s56, s28
    s_lshl_b32 s56, s56, 11
    s_lshl_b32 s33, s69, 9
    s_add_u32 s56, s56, s33
    s_add_u32 s56, s56, 65536
    v_cndmask_b32 v51, v59, v51, vcc
    s_lshl_b32 s57, s71, 2
    s_add_u32 s57, s57, s28
    s_bitcmp1_b32 s73, 2
    s_cselect_b32 s34, 112, 0
    s_add_u32 s57, s57, s34
    s_lshl_b32 s57, s57, 11
    s_add_u32 s57, s57, s33
    s_add_u32 s57, s57, 589824
    s_cmp_lt_u32 s73, 224
    s_cselect_b32 s57, s57, s35
    v_lshrrev_b32 v53, 2, v56
    v_lshlrev_b32 v53, 11, v53
    v_lshl_add_u32 v53, v55, 9, v53
    v_lshl_add_u32 v53, v7, 4, v53
    s_and_b32 s58, s30, -4
    s_add_u32 s58, s58, s28
    s_lshl_b32 s58, s58, 14
    s_lshl_b32 s33, s29, 6
    s_add_u32 s58, s58, s33
    s_add_u32 s58, s58, 65536
    v_lshlrev_b32 v54, 3, v56
    v_lshl_add_u32 v54, v55, 2, v54
    s_lshl_b32 s33, s28, 8
    s_add_u32 s33, s33, 147968
    v_add_u32 v54, s33, v54
    s_waitcnt vmcnt(0)
    v_lshlrev_b32 v24, 16, v8
    v_and_b32 v25, 0xffff0000, v8
    v_lshlrev_b32 v26, 16, v9
    v_and_b32 v27, 0xffff0000, v9
    v_lshlrev_b32 v28, 16, v10
    v_and_b32 v29, 0xffff0000, v10
    v_lshlrev_b32 v30, 16, v11
    v_and_b32 v31, 0xffff0000, v11
    v_lshlrev_b32 v32, 16, v12
    v_and_b32 v33, 0xffff0000, v12
    v_lshlrev_b32 v34, 16, v13
    v_and_b32 v35, 0xffff0000, v13
    v_lshlrev_b32 v36, 16, v14
    v_and_b32 v37, 0xffff0000, v14
    v_lshlrev_b32 v38, 16, v15
    v_and_b32 v39, 0xffff0000, v15
    v_pk_add_f32 v[40:41], v[24:25], v[26:27]
    v_pk_add_f32 v[42:43], v[28:29], v[30:31]
    v_pk_add_f32 v[44:45], v[32:33], v[34:35]
    v_pk_add_f32 v[46:47], v[36:37], v[38:39]
    v_pk_add_f32 v[40:41], v[40:41], v[42:43]
    v_pk_add_f32 v[44:45], v[44:45], v[46:47]
    v_pk_add_f32 v[40:41], v[40:41], v[44:45]
    v_add_f32 v16, v40, v41
    s_nop 1
    v_add_f32_dpp v16, v16, v16 row_ror:8 row_mask:0xf bank_mask:0xf
    s_nop 1
    v_add_f32_dpp v16, v16, v16 row_ror:4 row_mask:0xf bank_mask:0xf
    s_nop 1
    v_add_f32_dpp v16, v16, v16 row_ror:2 row_mask:0xf bank_mask:0xf
    s_nop 1
    v_add_f32_dpp v16, v16, v16 row_ror:1 row_mask:0xf bank_mask:0xf
    v_mov_b32 v5, v16
    s_nop 1
    v_permlane16_swap_b32 v16, v5
    v_add_f32 v16, v16, v5
    v_mul_f32 v16, 0xbb000000, v16
    v_mov_b32 v18, 0
    v_mov_b32 v19, 0
    v_pk_add_f32 v[40:41], v[24:25], v[16:17] op_sel_hi:[1,0]
    v_pk_fma_f32 v[18:19], v[40:41], v[40:41], v[18:19]
    v_pk_add_f32 v[40:41], v[26:27], v[16:17] op_sel_hi:[1,0]
    v_pk_fma_f32 v[18:19], v[40:41], v[40:41], v[18:19]
    v_pk_add_f32 v[40:41], v[28:29], v[16:17] op_sel_hi:[1,0]
    v_pk_fma_f32 v[18:19], v[40:41], v[40:41], v[18:19]
    v_pk_add_f32 v[40:41], v[30:31], v[16:17] op_sel_hi:[1,0]
    v_pk_fma_f32 v[18:19], v[40:41], v[40:41], v[18:19]
    v_pk_add_f32 v[40:41], v[32:33], v[16:17] op_sel_hi:[1,0]
    v_pk_fma_f32 v[18:19], v[40:41], v[40:41], v[18:19]
    v_pk_add_f32 v[40:41], v[34:35], v[16:17] op_sel_hi:[1,0]
    v_pk_fma_f32 v[18:19], v[40:41], v[40:41], v[18:19]
    v_pk_add_f32 v[40:41], v[36:37], v[16:17] op_sel_hi:[1,0]
    v_pk_fma_f32 v[18:19], v[40:41], v[40:41], v[18:19]
    v_pk_add_f32 v[40:41], v[38:39], v[16:17] op_sel_hi:[1,0]
    v_pk_fma_f32 v[18:19], v[40:41], v[40:41], v[18:19]
    v_add_f32 v18, v18, v19
    s_nop 1
    v_add_f32_dpp v18, v18, v18 row_ror:8 row_mask:0xf bank_mask:0xf
    s_nop 1
    v_add_f32_dpp v18, v18, v18 row_ror:4 row_mask:0xf bank_mask:0xf
    s_nop 1
    v_add_f32_dpp v18, v18, v18 row_ror:2 row_mask:0xf bank_mask:0xf
    s_nop 1
    v_add_f32_dpp v18, v18, v18 row_ror:1 row_mask:0xf bank_mask:0xf
    v_mov_b32 v5, v18
    s_nop 1
    v_permlane16_swap_b32 v18, v5
    v_add_f32 v18, v18, v5
    v_mul_f32 v18, 0x3b000000, v18
    v_cvt_pk_bf16_f32 v18, v18, v18
    v_lshlrev_b32 v18, 16, v18
    v_add_f32 v18, 0x3727c5ac, v18
    v_cvt_pk_bf16_f32 v18, v18, v18
    v_lshlrev_b32 v18, 16, v18
    v_sqrt_f32 v18, v18
    s_nop 0
    v_cvt_pk_bf16_f32 v18, v18, v18
    v_lshlrev_b32 v18, 16, v18
    v_rcp_f32 v18, v18
    v_cvt_pk_bf16_f32 v16, v16, v16
    v_lshlrev_b32 v16, 16, v16
    v_pk_add_f32 v[24:25], v[24:25], v[16:17] op_sel_hi:[1,0]
    v_cvt_pk_bf16_f32 v40, v24, v25
    v_pk_add_f32 v[26:27], v[26:27], v[16:17] op_sel_hi:[1,0]
    v_cvt_pk_bf16_f32 v41, v26, v27
    v_pk_add_f32 v[28:29], v[28:29], v[16:17] op_sel_hi:[1,0]
    v_cvt_pk_bf16_f32 v42, v28, v29
    v_pk_add_f32 v[30:31], v[30:31], v[16:17] op_sel_hi:[1,0]
    v_cvt_pk_bf16_f32 v43, v30, v31
    v_pk_add_f32 v[32:33], v[32:33], v[16:17] op_sel_hi:[1,0]
    v_cvt_pk_bf16_f32 v44, v32, v33
    v_pk_add_f32 v[34:35], v[34:35], v[16:17] op_sel_hi:[1,0]
    v_cvt_pk_bf16_f32 v45, v34, v35
    v_pk_add_f32 v[36:37], v[36:37], v[16:17] op_sel_hi:[1,0]
    v_cvt_pk_bf16_f32 v46, v36, v37
    v_pk_add_f32 v[38:39], v[38:39], v[16:17] op_sel_hi:[1,0]
    v_cvt_pk_bf16_f32 v47, v38, v39
    v_lshlrev_b32 v24, 16, v40
    v_and_b32 v25, 0xffff0000, v40
    v_pk_mul_f32 v[24:25], v[24:25], v[18:19] op_sel_hi:[1,0]
    v_cvt_pk_bf16_f32 v8, v24, v25
    v_lshlrev_b32 v26, 16, v41
    v_and_b32 v27, 0xffff0000, v41
    v_pk_mul_f32 v[26:27], v[26:27], v[18:19] op_sel_hi:[1,0]
    v_cvt_pk_bf16_f32 v9, v26, v27
    v_lshlrev_b32 v28, 16, v42
    v_and_b32 v29, 0xffff0000, v42
    v_pk_mul_f32 v[28:29], v[28:29], v[18:19] op_sel_hi:[1,0]
    v_cvt_pk_bf16_f32 v10, v28, v29
    v_lshlrev_b32 v30, 16, v43
    v_and_b32 v31, 0xffff0000, v43
    v_pk_mul_f32 v[30:31], v[30:31], v[18:19] op_sel_hi:[1,0]
    v_cvt_pk_bf16_f32 v11, v30, v31
    v_lshlrev_b32 v32, 16, v44
    v_and_b32 v33, 0xffff0000, v44
    v_pk_mul_f32 v[32:33], v[32:33], v[18:19] op_sel_hi:[1,0]
    v_cvt_pk_bf16_f32 v12, v32, v33
    v_lshlrev_b32 v34, 16, v45
    v_and_b32 v35, 0xffff0000, v45
    v_pk_mul_f32 v[34:35], v[34:35], v[18:19] op_sel_hi:[1,0]
    v_cvt_pk_bf16_f32 v13, v34, v35
    v_lshlrev_b32 v36, 16, v46
    v_and_b32 v37, 0xffff0000, v46
    v_pk_mul_f32 v[36:37], v[36:37], v[18:19] op_sel_hi:[1,0]
    v_cvt_pk_bf16_f32 v14, v36, v37
    v_lshlrev_b32 v38, 16, v47
    v_and_b32 v39, 0xffff0000, v47
    v_pk_mul_f32 v[38:39], v[38:39], v[18:19] op_sel_hi:[1,0]
    v_cvt_pk_bf16_f32 v15, v38, v39
    ds_write_b128 v48, v[8:11]
    ds_write_b128 v48, v[12:15] offset:16
    v_mov_b32 v5, 161792
    v_mov_b32 v4, 1
    s_mov_b64 exec, 1
    s_waitcnt lgkmcnt(0)
    ds_add_u32 v5, v4 offset:0
    s_mov_b64 exec, -1
    s_add_u32 s32, s32, 0x9e3779b1
    s_mov_b32 s68, 0xffffff00
    v_bfe_u32 v60, s32, 0, 8
    v_bfe_u32 v61, s32, 8, 8
    v_bfe_u32 v62, s32, 16, 8
    v_bfe_u32 v63, s32, 24, 8
    v_mov_b32 v57, 0x80
    s_getreg_b32 s34, hwreg(HW_REG_XCC_ID, 0, 4)
    v_xor_b32 v58, s34, v63
    v_mov_b32 v5, 161792
    s_mov_b32 s33, 0
L_lw_1:
    ds_read_b32 v4, v5 offset:0
    s_add_u32 s33, s33, 1
    s_waitcnt lgkmcnt(0)
    v_readfirstlane_b32 s34, v4
    s_cmp_ge_u32 s34, 8
    s_cbranch_scc1 L_lwe_2
    s_cmp_lt_u32 s33, 0x100000
    s_cbranch_scc1 L_lw_1
L_lwe_2:
    ds_read_b64_tr_b16 v[64:65], v49 offset:0
    ds_read_b64_tr_b16 v[66:67], v49 offset:512
    ds_read_b128 v[80:83], v52 offset:0
    ds_read_b64_tr_b16 v[68:69], v49 offset:4096
    ds_read_b64_tr_b16 v[70:71], v49 offset:4608
    ds_read_b128 v[84:87], v52 offset:64
    ds_read_b64_tr_b16 v[72:73], v49 offset:8192
    ds_read_b64_tr_b16 v[74:75], v49 offset:8704
    ds_read_b128 v[88:91], v52 offset:128
    ds_read_b64_tr_b16 v[76:77], v49 offset:12288
    ds_read_b64_tr_b16 v[78:79], v49 offset:12800
    ds_read_b128 v[92:95], v52 offset:192
    s_waitcnt lgkmcnt(9)
    v_mfma_f32_16x16x32_bf16 v[16:19], v[64:67], v[80:83], 0
    s_waitcnt lgkmcnt(6)
    v_mfma_f32_16x16x32_bf16 v[16:19], v[68:71], v[84:87], v[16:19]
    s_waitcnt lgkmcnt(3)
    v_mfma_f32_16x16x32_bf16 v[16:19], v[72:75], v[88:91], v[16:19]
    s_waitcnt lgkmcnt(0)
    v_mfma_f32_16x16x32_bf16 v[16:19], v[76:79], v[92:95], v[16:19]
    s_nop 7
    v_and_or_b32 v16, v16, s68, v60
    v_and_or_b32 v17, v17, s68, v61
    v_and_or_b32 v18, v18, s68, v62
    v_and_or_b32 v19, v19, s68, v58
    buffer_store_dwordx4 v[16:19], v51, s[44:47], s56 offen sc1
    v_mov_b32 v5, 161792
    s_mov_b32 s33, 0
L_lw_3:
    ds_read_b32 v4, v5 offset:8
    s_add_u32 s33, s33, 1
    s_waitcnt lgkmcnt(0)
    v_readfirstlane_b32 s34, v4
    s_cmp_ge_u32 s34, 4
    s_cbranch_scc1 L_lwe_4
    s_cmp_lt_u32 s33, 0x100000
    s_cbranch_scc1 L_lw_3
L_lwe_4:
    ds_read_b64_tr_b16 v[64:65], v49 offset:16384
    ds_read_b64_tr_b16 v[66:67], v49 offset:16896
    ds_read_b64_tr_b16 v[68:69], v49 offset:20480
    ds_read_b64_tr_b16 v[70:71], v49 offset:20992
    ds_read_b64_tr_b16 v[72:73], v49 offset:24576
    ds_read_b64_tr_b16 v[74:75], v49 offset:25088
    ds_read_b64_tr_b16 v[76:77], v49 offset:28672
    ds_read_b64_tr_b16 v[78:79], v49 offset:29184
    s_waitcnt lgkmcnt(6)
    v_mfma_f32_16x16x32_bf16 v[20:23], v[64:67], v[80:83], 0
    s_waitcnt lgkmcnt(4)
    v_mfma_f32_16x16x32_bf16 v[20:23], v[68:71], v[84:87], v[20:23]
    s_waitcnt lgkmcnt(2)
    v_mfma_f32_16x16x32_bf16 v[20:23], v[72:75], v[88:91], v[20:23]
    s_waitcnt lgkmcnt(0)
    v_mfma_f32_16x16x32_bf16 v[20:23], v[76:79], v[92:95], v[20:23]
    s_nop 7
    v_and_or_b32 v20, v20, s68, v60
    v_and_or_b32 v21, v21, s68, v61
    v_and_or_b32 v22, v22, s68, v62
    v_and_or_b32 v23, v23, s68, v63
    buffer_store_dwordx4 v[20:23], v51, s[44:47], s57 offen sc1
    s_waitcnt vmcnt(0)
    s_mov_b32 s33, 0
L_qg:
    buffer_load_dwordx4 v[24:27], v53, s[44:47], s58 offen sc1
    buffer_load_dwordx4 v[28:31], v53, s[44:47], s58 offen offset:1024 sc1
    s_add_u32 s33, s33, 1
    s_waitcnt vmcnt(0)
    v_xor_b32 v9, v27, v58
    v_bitop3_b32 v9, v9, v31, v58 bitop3:0xf6
    v_and_b32 v8, 0xf0, v9
    v_bitop3_b32 v8, v8, v24, v60 bitop3:0xf6
    v_bitop3_b32 v8, v8, v25, v61 bitop3:0xf6
    v_bitop3_b32 v8, v8, v26, v62 bitop3:0xf6
    v_bitop3_b32 v8, v8, v28, v60 bitop3:0xf6
    v_bitop3_b32 v8, v8, v29, v61 bitop3:0xf6
    v_bitop3_b32 v8, v8, v30, v62 bitop3:0xf6
    v_and_b32 v8, 0xff, v8
    v_cmp_ne_u32 vcc, 0, v8
    v_and_or_b32 v24, v24, s68, v57
    v_and_or_b32 v25, v25, s68, v57
    v_and_or_b32 v26, v26, s68, v57
    v_and_or_b32 v27, v27, s68, v57
    v_and_or_b32 v28, v28, s68, v57
    v_and_or_b32 v29, v29, s68, v57
    v_and_or_b32 v30, v30, s68, v57
    v_and_or_b32 v31, v31, s68, v57
    v_pk_add_f32 v[24:25], v[24:25], v[28:29]
    v_pk_add_f32 v[26:27], v[26:27], v[30:31]
    s_nop 1
    v_permlane32_swap_b32 v24, v26
    v_permlane32_swap_b32 v25, v27
    v_pk_add_f32 v[24:25], v[24:25], v[26:27]
    s_cbranch_vccz L_qg_ok
    s_cmp_lt_u32 s33, 0x4000
    s_cbranch_scc1 L_qg
L_qg_ok:
    v_cvt_pk_bf16_f32 v24, v24, v25
    ds_write_b32 v54, v24
    v_and_b32 v9, 15, v9
    v_mov_b32 v5, 161792
    v_cmp_ne_u32 vcc, 0, v9
    s_and_saveexec_b64 s[58:59], vcc
    ds_write_b32 v5, v9 offset:32
    s_mov_b64 exec, -1
    v_mov_b32 v5, 161792
    v_mov_b32 v4, 1
    s_mov_b64 exec, 1
    s_waitcnt lgkmcnt(0)
    ds_add_u32 v5, v4 offset:4
    s_mov_b64 exec, -1
    s_setprio 0
    v_lshlrev_b32 v53, 4, v0
    s_add_u32 s58, s72, s28
    s_lshl_b32 s58, s58, 11
    s_add_u32 s58, s58, 589824
    s_add_u32 s59, s58, 229376
    v_lshrrev_b32 v54, 2, v56
    v_mul_u32_u24 v54, 160, v54
    v_lshl_add_u32 v54, v7, 3, v54
    v_lshl_add_u32 v54, v55, 2, v54
    s_lshl_b32 s33, s28, 5
    s_add_u32 s33, s33, 151552
    v_add_u32 v54, s33, v54
    s_mov_b32 s33, 0
L_gg:
    s_sleep 2
    buffer_load_dwordx4 v[24:27], v53, s[44:47], s58 offen offset:0 sc1
    buffer_load_dwordx4 v[28:31], v53, s[44:47], s58 offen offset:1024 sc1
    buffer_load_dwordx4 v[32:35], v53, s[44:47], s59 offen offset:0 sc1
    buffer_load_dwordx4 v[36:39], v53, s[44:47], s59 offen offset:1024 sc1
    s_add_u32 s33, s33, 1
    s_waitcnt vmcnt(0)
    v_xor_b32 v8, v24, v60
    v_bitop3_b32 v8, v8, v25, v61 bitop3:0xf6
    v_bitop3_b32 v8, v8, v26, v62 bitop3:0xf6
    v_bitop3_b32 v8, v8, v27, v63 bitop3:0xf6
    v_bitop3_b32 v8, v8, v28, v60 bitop3:0xf6
    v_bitop3_b32 v8, v8, v29, v61 bitop3:0xf6
    v_bitop3_b32 v8, v8, v30, v62 bitop3:0xf6
    v_bitop3_b32 v8, v8, v31, v63 bitop3:0xf6
    v_bitop3_b32 v8, v8, v32, v60 bitop3:0xf6
    v_bitop3_b32 v8, v8, v33, v61 bitop3:0xf6
    v_bitop3_b32 v8, v8, v34, v62 bitop3:0xf6
    v_bitop3_b32 v8, v8, v35, v63 bitop3:0xf6
    v_bitop3_b32 v8, v8, v36, v60 bitop3:0xf6
    v_bitop3_b32 v8, v8, v37, v61 bitop3:0xf6
    v_bitop3_b32 v8, v8, v38, v62 bitop3:0xf6
    v_bitop3_b32 v8, v8, v39, v63 bitop3:0xf6
    v_and_b32 v8, 0xff, v8
    v_cmp_ne_u32 vcc, 0, v8
    s_cbranch_vccz L_gg_ok
    s_cmp_lt_u32 s33, 0x4000
    s_cbranch_scc1 L_gg
L_gg_ok:
    v_and_or_b32 v24, v24, s68, v57
    v_and_or_b32 v25, v25, s68, v57
    v_and_or_b32 v26, v26, s68, v57
    v_and_or_b32 v27, v27, s68, v57
    v_and_or_b32 v28, v28, s68, v57
    v_and_or_b32 v29, v29, s68, v57
    v_and_or_b32 v30, v30, s68, v57
    v_and_or_b32 v31, v31, s68, v57
    v_and_or_b32 v32, v32, s68, v57
    v_and_or_b32 v33, v33, s68, v57
    v_and_or_b32 v34, v34, s68, v57
    v_and_or_b32 v35, v35, s68, v57
    v_and_or_b32 v36, v36, s68, v57
    v_and_or_b32 v37, v37, s68, v57
    v_and_or_b32 v38, v38, s68, v57
    v_and_or_b32 v39, v39, s68, v57
    v_pk_add_f32 v[24:25], v[24:25], v[28:29]
    v_pk_add_f32 v[26:27], v[26:27], v[30:31]
    s_nop 1
    v_permlane32_swap_b32 v24, v26
    v_permlane32_swap_b32 v25, v27
    v_pk_add_f32 v[24:25], v[24:25], v[26:27]
    v_pk_add_f32 v[32:33], v[32:33], v[36:37]
    v_pk_add_f32 v[34:35], v[34:35], v[38:39]
    s_nop 1
    v_permlane32_swap_b32 v32, v34
    v_permlane32_swap_b32 v33, v35
    v_pk_add_f32 v[32:33], v[32:33], v[34:35]
    v_cvt_pk_bf16_f32 v24, v24, v24
    v_lshlrev_b32 v24, 16, v24
    v_cvt_pk_bf16_f32 v25, v25, v25
    v_lshlrev_b32 v25, 16, v25
    v_cvt_pk_bf16_f32 v32, v32, v32
    v_lshlrev_b32 v32, 16, v32
    v_cvt_pk_bf16_f32 v33, v33, v33
    v_lshlrev_b32 v33, 16, v33
    v_pk_mul_f32 v[24:25], v[24:25], v[32:33]
    v_cvt_pk_bf16_f32 v24, v24, v25
    ds_write_b32 v54, v24
    v_mov_b32 v5, 161792
    v_mov_b32 v4, 1
    s_mov_b64 exec, 1
    s_waitcnt lgkmcnt(0)
    ds_add_u32 v5, v4 offset:20
    s_mov_b64 exec, -1
    s_mul_i32 s33, s28, 2080
    s_add_u32 s33, s33, 153088
    v_lshl_add_u32 v8, v56, 4, s33
    s_lshl_b32 s33, s28, 5
    s_add_u32 s33, s33, 161536
    v_lshl_add_u32 v9, v7, 3, s33
    v_cmp_gt_u32 vcc, 32, v0
    v_mul_u32_u24 v12, 12, v56
    v_lshlrev_b32 v4, 3, v7
    v_cndmask_b32 v10, v59, v12, vcc
    v_lshrrev_b32 v109, v4, s32
    v_and_b32 v109, 0xff, v109
    s_and_b32 s55, s31, -4
    s_add_u32 s55, s55, s28
    s_lshl_b32 s55, s55, 2
    s_and_b32 s33, s31, 3
    s_add_u32 s55, s55, s33
    s_mul_i32 s55, s55, 384
    s_add_u32 s55, s55, 1048576
    v_mul_u32_u24 v11, 49152, v55
    v_add_u32 v11, v11, v12
    s_lshl_b32 s56, s28, 6
    s_add_u32 s56, s56, s30
    s_mul_i32 s56, s56, 1536
    s_add_u32 s56, s56, 1048576
    v_mul_u32_u24 v13, 288, v55
    v_lshl_add_u32 v13, v56, 3, v13
    s_mul_i32 s33, s28, 576
    s_add_u32 s33, s33, 148992
    v_add_u32 v13, s33, v13
    v_mul_u32_u24 v14, 288, v50
    v_lshl_add_u32 v14, v2, 4, v14
    v_add_u32 v14, 148992, v14
    v_mul_u32_u24 v15, 160, v50
    v_lshl_add_u32 v15, v2, 4, v15
    v_add_u32 v15, 151552, v15
    s_lshl_b32 s57, s29, 2
    s_add_u32 s57, s57, s28
    s_lshl_b32 s57, s57, 11
    s_lshr_b32 s33, s30, 2
    s_lshl_b32 s33, s33, 16
    s_add_u32 s57, s57, s33
    s_and_b32 s33, s30, 3
    s_lshl_b32 s33, s33, 9
    s_add_u32 s57, s57, s33
    s_add_u32 s57, s57, 65536
    v_lshrrev_b32 v3, 1, v2
    v_lshlrev_b32 v3, 5, v3
    v_and_b32 v4, 1, v2
    v_lshl_add_u32 v3, v4, 2, v3
    v_lshrrev_b32 v4, 2, v1
    v_lshl_add_u32 v3, v4, 3, v3
    v_lshlrev_b32 v3, 7, v3
    v_lshl_add_u32 v3, v7, 3, v3
    v_xor_b32 v4, s28, v4
    v_lshl_add_u32 v3, v4, 5, v3
    v_add_u32 v3, 114688, v3
    v_lshl_add_u32 v104, v7, 2, v2
    v_lshlrev_b32 v104, 1, v104
    s_lshl_b32 s54, s31, 5
    buffer_load_ushort v106, v104, s[36:39], s54 offen
    v_and_b32 v5, 12, v0
    v_cmp_eq_u32 vcc, 0, v5
    v_lshrrev_b32 v105, 2, v1
    v_lshlrev_b32 v105, 9, v105
    v_lshl_add_u32 v105, v2, 16, v105
    v_cndmask_b32 v104, v59, v104, vcc
    v_lshl_add_u32 v105, v7, 4, v105
    s_lshl_b32 s58, s30, 11
    s_lshl_b32 s33, s29, 6
    s_add_u32 s58, s58, s33
    s_add_u32 s58, s58, 65536
    s_add_u32 s59, s58, 0x40000
    v_cmp_eq_u32 vcc, 0, v0
    s_cmp_eq_u32 s2, 0
    s_cselect_b32 s67, 0, s35
    v_cndmask_b32 v107, v59, 0, vcc
    s_waitcnt vmcnt(0)
    v_lshlrev_b32 v106, 16, v106
    v_mov_b32 v5, 161792
    s_mov_b32 s33, 0
L_lw_5:
    ds_read_b32 v4, v5 offset:20
    s_add_u32 s33, s33, 1
    s_waitcnt lgkmcnt(0)
    v_readfirstlane_b32 s34, v4
    s_cmp_ge_u32 s34, 8
    s_cbranch_scc1 L_lwe_6
    s_sleep 4
    s_cmp_lt_u32 s33, 0x100000
    s_cbranch_scc1 L_lw_5
L_lwe_6:
    ds_read_b32 v4, v5 offset:32
    s_add_u32 s34, s32, 0x9e3779b1
    v_bfe_u32 v116, s34, 0, 8
    v_bfe_u32 v117, s34, 8, 8
    v_bfe_u32 v118, s34, 16, 8
    v_bfe_u32 v119, s34, 24, 8
    v_mov_b32 v108, s34
    s_waitcnt lgkmcnt(0)
    v_readfirstlane_b32 s74, v4
    ds_read_b128 v[88:91], v15 offset:0
    ds_read_b128 v[92:95], v15 offset:64
    ds_read_b64_tr_b16 v[80:81], v49 offset:32768
    ds_read_b64_tr_b16 v[82:83], v49 offset:33280
    ds_read_b64_tr_b16 v[84:85], v49 offset:36864
    ds_read_b64_tr_b16 v[86:87], v49 offset:37376
    s_waitcnt lgkmcnt(0)
    v_mfma_f32_16x16x32_bf16 v[112:115], v[80:83], v[88:91], 0
    v_mfma_f32_16x16x32_bf16 v[112:115], v[84:87], v[92:95], v[112:115]
    s_mov_b32 s66, 0
    v_not_b32 v128, v60
    v_not_b32 v132, v60
    v_not_b32 v136, v60
    v_not_b32 v140, v60
    v_not_b32 v144, v60
    v_not_b32 v148, v116
    v_not_b32 v152, v116
    s_cmp_lg_u32 s28, 3
    s_cbranch_scc1 L_noreg
    s_mul_i32 s61, s3, 4352
    s_add_u32 s61, s61, 4096
    s_lshr_b32 s75, s2, 3
    s_lshl_b32 s34, s75, 2
    v_mov_b32 v16, s34
    v_lshl_add_u32 v17, v56, 2, s61
    v_and_b32 v18, 7, v0
    s_cmp_eq_u32 s75, 0
    s_cselect_b32 s34, 4352, 0
    v_mul_u32_u24 v18, s34, v18
    s_add_u32 s52, s61, 128
    s_cmp_eq_u32 s75, 0
    s_cselect_b32 s34, 6144, s52
    v_add_u32 v18, s34, v18
    v_mov_b32 v23, s52
    v_cmp_gt_u32 vcc, 32, v0
    s_and_b32 s65, s32, s68
    s_and_b32 s64, s32, 0xffffe000
    v_cndmask_b32 v17, v18, v17, vcc
    v_mov_b32 v20, s64
    v_mov_b32 v21, s65
    v_cndmask_b32 v20, v20, v21, vcc
    v_mov_b32 v21, 0x2000
    v_mov_b32 v22, 0x100
    v_cndmask_b32 v21, v21, v22, vcc
    s_add_u32 s34, s61, 2048
    v_mov_b32 v22, s34
    v_mov_b32 v5, 161792
    s_mov_b32 s33, 0
    s_mov_b32 s63, 128
    s_add_u32 s62, s3, 32
    v_mov_b32 v25, -1
    v_mov_b32 v26, 0
    s_mov_b32 s63, -100
    s_mov_b32 s33, s3
L_reg:
    s_sleep 8
    ds_read_b32 v4, v5 offset:24
    s_add_u32 s33, s33, 1
    s_waitcnt lgkmcnt(0)
    v_or_b32 v18, s65, v4
    v_readfirstlane_b32 s34, v4
    s_mov_b64 exec, 1
    buffer_store_dword v18, v16, s[44:47], s61 offen
    s_mov_b64 exec, -1
    s_cmp_ge_u32 s34, 109
    s_cbranch_scc1 L_regx
    s_cmp_ge_u32 s33, 0x10000
    s_cbranch_scc1 L_noreg
    buffer_load_dword v19, v17, s[44:47], 0 offen sc1
    s_waitcnt vmcnt(0)
    v_xor_b32 v19, v20, v19
    v_cmp_gt_u32 vcc, v21, v19
    s_nop 1
    v_cndmask_b32 v19, v4, v19, vcc
    v_mov_b32 v24, v19
    v_readlane_b32 s48, v19, s62
    s_nop 1
    v_add_u32_dpp v19, v19, v19 row_ror:8 row_mask:0xf bank_mask:0xf
    s_nop 1
    v_add_u32_dpp v19, v19, v19 row_ror:4 row_mask:0xf bank_mask:0xf
    s_nop 1
    v_add_u32_dpp v19, v19, v19 row_ror:2 row_mask:0xf bank_mask:0xf
    s_nop 1
    v_add_u32_dpp v19, v19, v19 row_ror:1 row_mask:0xf bank_mask:0xf
    v_mov_b32 v18, v19
    s_nop 1
    v_permlane16_swap_b32 v19, v18
    v_add_u32 v19, v19, v18
    s_nop 0
    v_readlane_b32 s49, v19, 0
    v_readlane_b32 s50, v19, 32
    s_and_b32 s51, s33, 3
    s_or_b32 s51, s51, s75
    s_cbranch_scc1 L_nopub
    s_or_b32 s51, s64, s49
    v_mov_b32 v18, s51
    s_mov_b64 exec, 1
    buffer_store_dword v18, v22, s[44:47], 0 offen sc1
    s_mov_b64 exec, -1
L_nopub:
    s_cmp_lg_u32 vcc_hi, -1
    s_cbranch_scc1 L_local
    s_cmp_lg_u32 s75, 0
    s_cbranch_scc1 L_member
    v_cmp_ne_u32 vcc, v24, v25
    v_subrev_u32 v18, s49, v24
    v_mov_b32 v25, v24
    v_cndmask_b32 v26, v26, v18, vcc
    v_mov_b32 v18, v26
    v_readlane_b32 s48, v26, s62
    s_nop 1
    v_add_u32_dpp v18, v18, v18 row_ror:4 row_mask:0xf bank_mask:0xf
    s_nop 1
    v_add_u32_dpp v18, v18, v18 row_ror:2 row_mask:0xf bank_mask:0xf
    s_nop 1
    v_add_u32_dpp v18, v18, v18 row_ror:1 row_mask:0xf bank_mask:0xf
    s_sub_i32 s48, s48, s63
    s_ashr_i32 s48, s48, 3
    s_add_i32 s63, s63, s48
    v_readlane_b32 s48, v18, 32
    s_ashr_i32 s48, s48, 3
    s_sub_i32 s48, s48, s63
    s_add_i32 s48, s48, 4096
    s_and_b32 s48, s48, 0x1fff
    s_or_b32 s51, s64, s48
    v_mov_b32 v18, s51
    s_mov_b64 exec, 1
    buffer_store_dword v18, v23, s[44:47], 0 offen
    s_mov_b64 exec, -1
L_member:
    s_add_i32 s49, s49, s48
    s_sub_i32 s49, s49, 4096
L_local:
    s_lshl_b32 s34, s34, 5
    s_add_i32 s34, s34, 32
    s_cmp_gt_i32 s49, s34
    s_cselect_b32 s34, 2, 0
    v_mov_b32 v18, s34
    ds_write_b32 v5, v18 offset:16
    s_branch L_reg
L_regx:
L_noreg:
    s_mov_b32 s33, 0
    s_setprio 2
    s_barrier
L_tail:
    ds_read_b64 v[16:17], v9
    ds_read_b128 v[24:27], v8 offset:0
    ds_read_b128 v[28:31], v8 offset:512
    ds_read_b128 v[32:35], v8 offset:1024
    ds_read_b128 v[36:39], v8 offset:1536
    s_cmp_lg_u32 s74, 0
    s_waitcnt lgkmcnt(4)
    v_max_f32_dpp v18, v16, v16 quad_perm:[1,0,3,2] row_mask:0xf bank_mask:0xf
    s_nop 1
    v_max_f32_dpp v18, v18, v18 quad_perm:[2,3,0,1] row_mask:0xf bank_mask:0xf
    v_sub_f32 v16, v16, v18
    v_exp_f32 v16, v16
    s_nop 0
    v_mul_f32 v19, v16, v17
    s_nop 1
    v_add_f32_dpp v19, v19, v19 quad_perm:[1,0,3,2] row_mask:0xf bank_mask:0xf
    s_nop 1
    v_add_f32_dpp v19, v19, v19 quad_perm:[2,3,0,1] row_mask:0xf bank_mask:0xf
    v_log_f32 v17, v19
    s_waitcnt lgkmcnt(3)
    v_mul_f32_dpp v20, v16, v24 quad_perm:[0,0,0,0] row_mask:0xf bank_mask:0xf
    v_mul_f32_dpp v21, v16, v25 quad_perm:[0,0,0,0] row_mask:0xf bank_mask:0xf
    v_mul_f32_dpp v22, v16, v26 quad_perm:[0,0,0,0] row_mask:0xf bank_mask:0xf
    v_mul_f32_dpp v23, v16, v27 quad_perm:[0,0,0,0] row_mask:0xf bank_mask:0xf
    v_add_f32 v17, v18, v17
    v_rcp_f32 v18, v19
    s_waitcnt lgkmcnt(2)
    v_fmac_f32_dpp v20, v16, v28 quad_perm:[1,1,1,1] row_mask:0xf bank_mask:0xf
    v_fmac_f32_dpp v21, v16, v29 quad_perm:[1,1,1,1] row_mask:0xf bank_mask:0xf
    v_fmac_f32_dpp v22, v16, v30 quad_perm:[1,1,1,1] row_mask:0xf bank_mask:0xf
    v_fmac_f32_dpp v23, v16, v31 quad_perm:[1,1,1,1] row_mask:0xf bank_mask:0xf
    s_waitcnt lgkmcnt(1)
    v_fmac_f32_dpp v20, v16, v32 quad_perm:[2,2,2,2] row_mask:0xf bank_mask:0xf
    v_fmac_f32_dpp v21, v16, v33 quad_perm:[2,2,2,2] row_mask:0xf bank_mask:0xf
    v_fmac_f32_dpp v22, v16, v34 quad_perm:[2,2,2,2] row_mask:0xf bank_mask:0xf
    v_fmac_f32_dpp v23, v16, v35 quad_perm:[2,2,2,2] row_mask:0xf bank_mask:0xf
    s_waitcnt lgkmcnt(0)
    v_fmac_f32_dpp v20, v16, v36 quad_perm:[3,3,3,3] row_mask:0xf bank_mask:0xf
    v_fmac_f32_dpp v21, v16, v37 quad_perm:[3,3,3,3] row_mask:0xf bank_mask:0xf
    v_fmac_f32_dpp v22, v16, v38 quad_perm:[3,3,3,3] row_mask:0xf bank_mask:0xf
    v_fmac_f32_dpp v23, v16, v39 quad_perm:[3,3,3,3] row_mask:0xf bank_mask:0xf
    v_pk_mul_f32 v[20:21], v[20:21], v[18:19] op_sel_hi:[1,0]
    v_pk_mul_f32 v[22:23], v[22:23], v[18:19] op_sel_hi:[1,0]
    v_cvt_pk_bf16_f32 v20, v20, v21
    v_cvt_pk_bf16_f32 v21, v22, v23
    v_and_or_b32 v22, v17, s68, v109
    s_cbranch_scc1 L_far
    buffer_store_dwordx3 v[20:22], v10, s[44:47], s55 offen
    s_branch L_pub
L_far:
    buffer_store_dwordx3 v[20:22], v10, s[44:47], s55 offen sc1
L_pub:
    buffer_load_dwordx3 v[128:130], v11, s[44:47], s56 offen offset:0 sc1
    buffer_load_dwordx3 v[132:134], v11, s[44:47], s56 offen offset:384 sc1
    buffer_load_dwordx3 v[136:138], v11, s[44:47], s56 offen offset:768 sc1
    buffer_load_dwordx3 v[140:142], v11, s[44:47], s56 offen offset:1152 sc1
    s_branch L_tg1
L_tg:
    s_cmp_eq_u64 s[50:51], 0
    s_cbranch_scc1 L_c_7
    buffer_load_dwordx3 v[128:130], v11, s[44:47], s56 offen offset:0 sc1
L_c_7:
    s_cmp_eq_u64 s[52:53], 0
    s_cbranch_scc1 L_c_8
    buffer_load_dwordx3 v[132:134], v11, s[44:47], s56 offen offset:384 sc1
L_c_8:
    s_cmp_eq_u64 s[62:63], 0
    s_cbranch_scc1 L_c_9
    buffer_load_dwordx3 v[136:138], v11, s[44:47], s56 offen offset:768 sc1
L_c_9:
    s_cmp_eq_u64 s[64:65], 0
    s_cbranch_scc1 L_c_10
    buffer_load_dwordx3 v[140:142], v11, s[44:47], s56 offen offset:1152 sc1
L_c_10:
L_tg1:
    s_add_u32 s33, s33, 1
    s_waitcnt vmcnt(0)
    v_xor_b32 v24, v130, v109
    v_xor_b32 v25, v134, v109
    v_xor_b32 v26, v138, v109
    v_xor_b32 v27, v142, v109
    v_and_b32 v40, 0xff, v24
    v_and_b32 v41, 0xff, v25
    v_and_b32 v42, 0xff, v26
    v_and_b32 v43, 0xff, v27
    v_cmp_ne_u32 s[50:51], 0, v40
    v_cmp_ne_u32 s[52:53], 0, v41
    v_cmp_ne_u32 s[62:63], 0, v42
    v_cmp_ne_u32 s[64:65], 0, v43
    v_max3_f32 v18, v24, v25, v26
    v_max_f32 v18, v18, v27
    s_or_b64 vcc, s[50:51], s[52:53]
    s_or_b64 vcc, vcc, s[62:63]
    s_or_b64 vcc, vcc, s[64:65]
    s_cbranch_scc0 L_tg_ok
    s_cmp_le_u32 s33, 0x20000
    s_cbranch_scc1 L_tg
L_tg_ok:
    v_sub_f32 v32, v24, v18
    v_sub_f32 v34, v25, v18
    v_sub_f32 v36, v26, v18
    v_sub_f32 v38, v27, v18
    v_exp_f32 v32, v32
    v_exp_f32 v34, v34
    v_exp_f32 v36, v36
    v_exp_f32 v38, v38
    v_lshlrev_b32 v160, 16, v128
    v_and_b32 v161, 0xffff0000, v128
    v_lshlrev_b32 v162, 16, v129
    v_and_b32 v163, 0xffff0000, v129
    v_add_f32 v18, v32, v34
    v_add_f32 v19, v36, v38
    v_lshlrev_b32 v164, 16, v132
    v_and_b32 v165, 0xffff0000, v132
    v_lshlrev_b32 v166, 16, v133
    v_and_b32 v167, 0xffff0000, v133
    v_add_f32 v18, v18, v19
    v_rcp_f32 v18, v18
    v_lshlrev_b32 v168, 16, v136
    v_and_b32 v169, 0xffff0000, v136
    v_lshlrev_b32 v170, 16, v137
    v_and_b32 v171, 0xffff0000, v137
    v_lshlrev_b32 v172, 16, v140
    v_and_b32 v173, 0xffff0000, v140
    v_lshlrev_b32 v174, 16, v141
    v_and_b32 v175, 0xffff0000, v141
    v_pk_mul_f32 v[40:41], v[160:161], v[32:33] op_sel_hi:[1,0]
    v_pk_mul_f32 v[42:43], v[162:163], v[32:33] op_sel_hi:[1,0]
    v_pk_fma_f32 v[40:41], v[164:165], v[34:35], v[40:41] op_sel_hi:[1,0,1]
    v_pk_fma_f32 v[42:43], v[166:167], v[34:35], v[42:43] op_sel_hi:[1,0,1]
    v_pk_fma_f32 v[40:41], v[168:169], v[36:37], v[40:41] op_sel_hi:[1,0,1]
    v_pk_fma_f32 v[42:43], v[170:171], v[36:37], v[42:43] op_sel_hi:[1,0,1]
    v_pk_fma_f32 v[40:41], v[172:173], v[38:39], v[40:41] op_sel_hi:[1,0,1]
    v_pk_fma_f32 v[42:43], v[174:175], v[38:39], v[42:43] op_sel_hi:[1,0,1]
    v_pk_mul_f32 v[40:41], v[40:41], v[18:19] op_sel_hi:[1,0]
    v_pk_mul_f32 v[42:43], v[42:43], v[18:19] op_sel_hi:[1,0]
    v_cvt_pk_bf16_f32 v40, v40, v41
    v_cvt_pk_bf16_f32 v41, v42, v43
    ds_write_b64 v13, v[40:41]
    s_waitcnt lgkmcnt(0)
    s_barrier
    ds_read_b64_tr_b16 v[64:65], v3 offset:0
    ds_read_b64_tr_b16 v[66:67], v3 offset:256
    ds_read_b128 v[24:27], v14 offset:0
    ds_read_b64_tr_b16 v[68:69], v3 offset:8192
    ds_read_b64_tr_b16 v[70:71], v3 offset:8448
    ds_read_b128 v[28:31], v14 offset:64
    ds_read_b64_tr_b16 v[72:73], v3 offset:128
    ds_read_b64_tr_b16 v[74:75], v3 offset:384
    ds_read_b128 v[32:35], v14 offset:128
    ds_read_b64_tr_b16 v[76:77], v3 offset:8320
    ds_read_b64_tr_b16 v[78:79], v3 offset:8576
    ds_read_b128 v[36:39], v14 offset:192
    s_waitcnt lgkmcnt(9)
    v_mfma_f32_16x16x32_bf16 v[96:99], v[64:67], v[24:27], v[112:115]
    s_waitcnt lgkmcnt(6)
    v_mfma_f32_16x16x32_bf16 v[96:99], v[68:71], v[28:31], v[96:99]
    s_waitcnt lgkmcnt(3)
    v_mfma_f32_16x16x32_bf16 v[96:99], v[72:75], v[32:35], v[96:99]
    s_waitcnt lgkmcnt(0)
    v_mfma_f32_16x16x32_bf16 v[96:99], v[76:79], v[36:39], v[96:99]
    s_nop 7
    v_and_or_b32 v96, v96, s68, v116
    v_and_or_b32 v97, v97, s68, v117
    v_and_or_b32 v98, v98, s68, v118
    v_and_or_b32 v99, v99, s68, v119
    buffer_store_dwordx4 v[96:99], v51, s[44:47], s57 offen sc1
    s_cmp_lg_u32 s28, 0
    s_cbranch_scc1 L_hend
    s_mov_b32 s33, s66
    s_mov_b64 s[48:49], -1
    s_mov_b64 s[50:51], -1
L_fg:
    s_cmp_lg_u32 s48, 0
    s_cselect_b32 s48, -1, 0
    s_cmp_lg_u32 s49, 0
    s_cselect_b32 s49, -1, 0
    s_cmp_lg_u32 s50, 0
    s_cselect_b32 s50, -1, 0
    s_cmp_lg_u32 s51, 0
    s_cselect_b32 s51, -1, 0
    s_mov_b64 exec, s[48:49]
    buffer_load_dwordx4 v[148:151], v105, s[44:47], s58 offen sc1
    s_mov_b64 exec, s[50:51]
    buffer_load_dwordx4 v[152:155], v105, s[44:47], s59 offen sc1
    s_mov_b64 exec, -1
    s_add_u32 s33, s33, 1
    s_waitcnt vmcnt(14)
    v_xor_b32 v20, v148, v116
    v_xor_b32 v21, v149, v117
    v_xor_b32 v22, v150, v118
    v_xor_b32 v23, v151, v119
    v_or3_b32 v16, v20, v21, v22
    v_bitop3_b32 v16, v16, v23, s68 bitop3:0x54
    v_xor_b32 v24, v152, v116
    v_xor_b32 v25, v153, v117
    v_xor_b32 v26, v154, v118
    v_xor_b32 v27, v155, v119
    v_or3_b32 v17, v24, v25, v26
    v_bitop3_b32 v17, v17, v27, s68 bitop3:0x54
    v_cmp_ne_u32 s[48:49], 0, v16
    v_cmp_ne_u32 s[50:51], 0, v17
    v_pk_add_f32 v[28:29], v[20:21], v[24:25]
    v_pk_add_f32 v[30:31], v[22:23], v[26:27]
    s_or_b64 vcc, s[48:49], s[50:51]
    s_cbranch_scc0 L_fg_ok
    s_cmp_le_u32 s33, 0x20000
    s_cbranch_scc1 L_fg
L_fg_ok:
    v_permlane32_swap_b32 v28, v30
    v_permlane32_swap_b32 v29, v31
    v_pk_add_f32 v[20:21], v[28:29], v[30:31]
    s_nop 1
    v_permlane16_swap_b32 v20, v21
    v_add_f32 v20, v20, v21
    s_nop 1
    v_add_f32_dpp v20, v20, v20 row_ror:4 row_mask:0xf bank_mask:0xf
    s_nop 1
    v_add_f32_dpp v20, v20, v20 row_ror:8 row_mask:0xf bank_mask:0xf
    v_add_f32 v20, v106, v20
    v_cvt_pk_bf16_f32 v20, v20, v20
    buffer_store_short v20, v104, s[40:43], s54 offen
    buffer_store_dword v108, v107, s[44:47], s67 offen
L_hend:
    s_branch L_exit
L_stream:
    s_sub_u32 s28, s28, 4
    v_lshrrev_b32 v5, 3, v0
    v_and_b32 v6, 7, v0
    v_lshlrev_b32 v6, 4, v6
    v_lshl_add_u32 v24, v5, 13, v6
    v_mul_u32_u24 v25, 3584, v5
    v_add_u32 v25, v25, v6
    v_lshl_add_u32 v26, v5, 10, v6
    s_lshl_b32 s34, s69, 2
    s_add_u32 s34, s34, s28
    s_lshl_b32 s56, s34, 18
    s_lshl_b32 s33, s70, 7
    s_add_u32 s56, s56, s33
    s_mul_i32 s57, s34, 114688
    s_lshl_b32 s33, s71, 7
    s_add_u32 s57, s57, s33
    s_lshl_b32 s63, s28, 12
    s_add_u32 m0, s63, 98304
    s_waitcnt lgkmcnt(0)
    s_mov_b32 s36, s10
    s_and_b32 s37, s11, 0xffff
    s_mov_b32 s38, 4194304
    s_mov_b32 s39, 0x20000
    buffer_load_dwordx4 v24, s[36:39], s56 offen nt lds
    s_add_u32 m0, m0, 1024
    s_add_u32 s56, s56, 65536
    buffer_load_dwordx4 v24, s[36:39], s56 offen nt lds
    s_add_u32 m0, m0, 1024
    s_add_u32 s56, s56, 65536
    buffer_load_dwordx4 v24, s[36:39], s56 offen nt lds
    s_add_u32 m0, m0, 1024
    s_add_u32 s56, s56, 65536
    buffer_load_dwordx4 v24, s[36:39], s56 offen nt lds
    s_add_u32 m0, s63, 114688
    s_bitcmp1_b32 s73, 2
    s_cselect_b32 s40, s18, s16
    s_cselect_b32 s41, s19, s17
    s_and_b32 s41, s41, 0xffff
    s_cmp_lt_u32 s73, 224
    s_cselect_b32 s42, 1835008, 0
    s_mov_b32 s43, 0x20000
    buffer_load_dwordx4 v25, s[40:43], s57 offen nt lds
    s_barrier
    v_lshlrev_b32 v4, 4, v0
    v_lshlrev_b32 v5, 2, v2
    v_xor_b32 v5, v5, v1
    v_lshlrev_b32 v5, 4, v5
    v_lshl_add_u32 v16, v2, 8, v5
    v_xor_b32 v17, 16, v16
    v_xor_b32 v18, 32, v16
    v_xor_b32 v19, 48, v16
    s_mul_i32 s64, s28, 24576
    s_add_u32 s65, s64, 4096
    s_mov_b32 s66, s64
    s_add_u32 s67, s64, 24576
    s_lshl_b32 s52, s28, 12
    s_and_b32 s34, s31, 1
    s_lshl_b32 s34, s34, 16
    s_add_u32 s52, s52, s34
    s_and_b32 s34, s31, 2
    s_lshl_b32 s34, s34, 19
    s_add_u32 s52, s52, s34
    s_mov_b32 s59, 0x8000
    s_mov_b32 s61, 0x8000
    s_add_u32 s53, s52, 0x4000
    s_mov_b32 s54, s52
    s_mov_b32 s55, s53
    s_mov_b32 s48, 0x3db504f3
    s_mov_b32 s49, 0x3fb8aa3b
    s_mov_b32 s50, 0x05040100
    s_mov_b32 s51, 0x07060302
    s_mov_b32 s60, 0xffff0000
    v_and_b32 v6, 3, v1
    v_lshrrev_b32 v5, 2, v1
    v_lshlrev_b32 v7, 10, v6
    v_lshl_add_u32 v7, v5, 8, v7
    v_xor_b32 v13, v1, v2
    v_lshl_add_u32 v56, v13, 4, v7
    v_xor_b32 v57, 64, v56
    v_xor_b32 v58, 128, v56
    v_xor_b32 v59, 192, v56
    v_mul_u32_u24 v14, 2080, v6
    v_lshl_add_u32 v14, v2, 6, v14
    v_lshl_add_u32 v14, v5, 4, v14
    s_lshl_b32 s34, s28, 9
    s_add_u32 s34, s34, 153088
    v_add_u32 v14, s34, v14
    s_lshl_b32 s34, s28, 3
    s_add_u32 s34, s34, 161536
    v_lshl_add_u32 v15, v6, 5, s34
    v_lshlrev_b32 v3, 8, v6
    v_lshl_add_u32 v3, v2, 4, v3
    v_add_u32 v3, 147968, v3
    v_lshlrev_b32 v12, 6, v2
    v_lshl_add_u32 v12, v6, 4, v12
    s_add_u32 s34, s63, 98304
    v_add_u32 v12, s34, v12
    v_mov_b32 v96, 0
    v_mov_b32 v97, 0
    v_mov_b32 v98, 0
    v_mov_b32 v99, 0
    v_mov_b32 v100, 0
    v_mov_b32 v101, 0
    v_mov_b32 v102, 0
    v_mov_b32 v103, 0
    v_mov_b32 v104, 0
    v_mov_b32 v105, 0
    v_mov_b32 v106, 0
    v_mov_b32 v107, 0
    v_mov_b32 v108, 0
    v_mov_b32 v109, 0
    v_mov_b32 v110, 0
    v_mov_b32 v111, 0
    v_mov_b32 v112, 0
    v_mov_b32 v113, 0
    v_mov_b32 v114, 0
    v_mov_b32 v115, 0
    v_mov_b32 v116, 0
    v_mov_b32 v117, 0
    v_mov_b32 v118, 0
    v_mov_b32 v119, 0
    v_mov_b32 v120, 0
    v_mov_b32 v121, 0
    v_mov_b32 v122, 0
    v_mov_b32 v123, 0
    v_mov_b32 v124, 0
    v_mov_b32 v125, 0
    v_mov_b32 v126, 0
    v_mov_b32 v127, 0
    v_mov_b32 v8, 0xff7fffff
    v_mov_b32 v10, 0
    v_mov_b32 v11, 0
    s_waitcnt vmcnt(4)
    s_add_u32 m0, m0, 1024
    s_add_u32 s57, s57, 28672
    buffer_load_dwordx4 v25, s[40:43], s57 offen nt lds
    s_waitcnt vmcnt(4)
    s_add_u32 m0, m0, 1024
    s_add_u32 s57, s57, 28672
    buffer_load_dwordx4 v25, s[40:43], s57 offen nt lds
    s_waitcnt vmcnt(4)
    s_add_u32 m0, m0, 1024
    s_add_u32 s57, s57, 28672
    buffer_load_dwordx4 v25, s[40:43], s57 offen nt lds
    s_waitcnt vmcnt(4)
    v_mov_b32 v7, 161792
    v_mov_b32 v6, 1
    s_mov_b64 exec, 1
    s_waitcnt lgkmcnt(0)
    ds_add_u32 v7, v6 offset:0
    s_mov_b64 exec, -1
    s_lshr_b32 s34, s63, 1
    s_add_u32 m0, s34, 131072
    s_mov_b32 s40, s20
    s_and_b32 s41, s21, 0xffff
    s_mov_b32 s42, 1835008
    s_lshl_b32 s33, s29, 7
    s_add_u32 s57, s72, s28
    s_lshl_b32 s57, s57, 14
    s_add_u32 s57, s57, s33
    s_add_u32 s58, s57, 8192
    s_and_b32 s34, s30, 1
    s_lshl_b32 s34, s34, 2
    s_add_u32 s34, s34, s28
    s_cmp_eq_u32 s34, 4
    s_cselect_b32 s57, s35, s57
    s_cmp_eq_u32 s34, 3
    s_cselect_b32 s58, s35, s58
    buffer_load_dwordx4 v26, s[40:43], s57 offen nt lds
    s_waitcnt vmcnt(4)
    s_add_u32 m0, m0, 1024
    s_nop 0
    buffer_load_dwordx4 v26, s[40:43], s58 offen nt lds
    s_waitcnt vmcnt(4)
    s_lshr_b32 s33, s31, 2
    s_lshl_b32 s33, s33, 21
    s_add_u32 s36, s6, s33
    s_addc_u32 s37, s7, 0
    s_and_b32 s37, s37, 0xffff
    s_mov_b32 s38, 2097152
    s_add_u32 s40, s8, s33
    s_addc_u32 s41, s9, 0
    s_and_b32 s41, s41, 0xffff
    s_mov_b32 s42, 2097152
    s_mov_b32 m0, s64
    s_nop 0
    buffer_load_dwordx4 v16, s[36:39], s52 offen offset:0 nt lds
    s_waitcnt vmcnt(4)
    buffer_load_dwordx4 v17, s[36:39], s52 offen offset:1024 nt lds
    s_waitcnt vmcnt(4)
    v_mov_b32 v7, 161792
    v_mov_b32 v6, 1
    s_mov_b64 exec, 1
    s_waitcnt lgkmcnt(0)
    ds_add_u32 v7, v6 offset:8
    s_mov_b64 exec, -1
    buffer_load_dwordx4 v18, s[36:39], s52 offen offset:2048 nt lds
    s_waitcnt vmcnt(4)
    buffer_load_dwordx4 v19, s[36:39], s52 offen offset:3072 nt lds
    s_waitcnt vmcnt(4)
    s_mov_b32 m0, s65
    s_nop 0
    buffer_load_dwordx4 v16, s[36:39], s53 offen offset:0 nt lds
    s_waitcnt vmcnt(4)
    v_mov_b32 v7, 161792
    v_mov_b32 v6, 1
    s_mov_b64 exec, 1
    s_waitcnt lgkmcnt(0)
    ds_add_u32 v7, v6 offset:20
    s_mov_b64 exec, -1
    buffer_load_dwordx4 v17, s[36:39], s53 offen offset:1024 nt lds
    s_waitcnt vmcnt(4)
    buffer_load_dwordx4 v18, s[36:39], s53 offen offset:2048 nt lds
    s_waitcnt vmcnt(4)
    buffer_load_dwordx4 v19, s[36:39], s53 offen offset:3072 nt lds
    s_waitcnt vmcnt(4)
    s_add_u32 s52, s52, s59
    s_add_u32 s53, s53, s59
    s_xor_b32 s59, s59, 0x10000
    s_add_u32 s64, s64, 8192
    s_cmp_eq_u32 s64, s67
    s_cselect_b32 s64, s66, s64
    s_add_u32 s65, s64, 4096
    s_mov_b32 m0, s64
    s_nop 0
    buffer_load_dwordx4 v16, s[36:39], s52 offen offset:0 nt lds
    s_waitcnt vmcnt(4)
    buffer_load_dwordx4 v17, s[36:39], s52 offen offset:1024 nt lds
    s_waitcnt vmcnt(4)
    buffer_load_dwordx4 v18, s[36:39], s52 offen offset:2048 nt lds
    s_waitcnt vmcnt(4)
    buffer_load_dwordx4 v19, s[36:39], s52 offen offset:3072 nt lds
    s_waitcnt vmcnt(4)
    s_mov_b32 m0, s65
    s_nop 0
    buffer_load_dwordx4 v16, s[36:39], s53 offen offset:0 nt lds
    s_waitcnt vmcnt(4)
    buffer_load_dwordx4 v17, s[36:39], s53 offen offset:1024 nt lds
    s_waitcnt vmcnt(4)
    buffer_load_dwordx4 v18, s[36:39], s53 offen offset:2048 nt lds
    s_waitcnt vmcnt(4)
    buffer_load_dwordx4 v19, s[36:39], s53 offen offset:3072 nt lds
    s_waitcnt vmcnt(4)
    s_add_u32 s52, s52, s59
    s_add_u32 s53, s53, s59
    s_xor_b32 s59, s59, 0x10000
    s_add_u32 s64, s64, 8192
    s_cmp_eq_u32 s64, s67
    s_cselect_b32 s64, s66, s64
    s_add_u32 s65, s64, 4096
    s_mov_b32 m0, s64
    s_nop 0
    buffer_load_dwordx4 v16, s[36:39], s52 offen offset:0 nt lds
    s_waitcnt vmcnt(4)
    buffer_load_dwordx4 v17, s[36:39], s52 offen offset:1024 nt lds
    s_waitcnt vmcnt(4)
    buffer_load_dwordx4 v18, s[36:39], s52 offen offset:2048 nt lds
    s_waitcnt vmcnt(4)
    buffer_load_dwordx4 v19, s[36:39], s52 offen offset:3072 nt lds
    s_waitcnt vmcnt(4)
    s_mov_b32 m0, s65
    s_nop 0
    buffer_load_dwordx4 v16, s[36:39], s53 offen offset:0 nt lds
    s_waitcnt vmcnt(4)
    buffer_load_dwordx4 v17, s[36:39], s53 offen offset:1024 nt lds
    s_waitcnt vmcnt(4)
    buffer_load_dwordx4 v18, s[36:39], s53 offen offset:2048 nt lds
    s_waitcnt vmcnt(4)
    buffer_load_dwordx4 v19, s[36:39], s53 offen offset:3072 nt lds
    s_add_u32 s52, s52, s59
    s_add_u32 s53, s53, s59
    s_xor_b32 s59, s59, 0x10000
    s_add_u32 s64, s64, 8192
    s_cmp_eq_u32 s64, s67
    s_cselect_b32 s64, s66, s64
    s_add_u32 s65, s64, 4096
    v_mov_b32 v7, 161792
    s_mov_b32 s33, 0
L_lw_11:
    ds_read_b32 v6, v7 offset:4
    s_add_u32 s33, s33, 1
    s_waitcnt lgkmcnt(0)
    v_readfirstlane_b32 s34, v6
    s_cmp_ge_u32 s34, 4
    s_cbranch_scc1 L_lwe_12
    s_sleep 1
    s_cmp_lt_u32 s33, 0x100000
    s_cbranch_scc1 L_lw_11
L_lwe_12:
    ds_read_b128 v[32:35], v3 offset:0
    ds_read_b128 v[36:39], v3 offset:64
    ds_read_b128 v[40:43], v3 offset:128
    ds_read_b128 v[44:47], v3 offset:192
    s_mov_b32 s62, 0
    s_mov_b64 vcc, 0
    v_mov_b32 v27, 161792
    v_mov_b32 v28, 1
    v_mov_b32 v24, 3
.p2align 6
L_k:
    v_add_u32 v20, s64, v56
    v_add_u32 v21, s64, v57
    v_add_u32 v22, s64, v58
    v_add_u32 v23, s64, v59
    s_waitcnt vmcnt(16)
    ds_read_b128 v[128:131], v20 offset:0
    ds_read_b128 v[132:135], v21 offset:0
    ds_read_b128 v[136:139], v22 offset:0
    ds_read_b128 v[140:143], v23 offset:0
    ds_read_b128 v[144:147], v20 offset:4096
    ds_read_b128 v[148:151], v21 offset:4096
    ds_read_b128 v[152:155], v22 offset:4096
    ds_read_b128 v[156:159], v23 offset:4096
    s_cmp_ge_u32 s62, 13
    s_waitcnt lgkmcnt(4)
    v_mfma_f32_16x16x32_bf16 v[64:67], v[128:131], v[32:35], 0
    v_mfma_f32_16x16x32_bf16 v[64:67], v[132:135], v[36:39], v[64:67]
    v_mfma_f32_16x16x32_bf16 v[64:67], v[136:139], v[40:43], v[64:67]
    v_mfma_f32_16x16x32_bf16 v[64:67], v[140:143], v[44:47], v[64:67]
    s_waitcnt lgkmcnt(0)
    v_mfma_f32_16x16x32_bf16 v[68:71], v[144:147], v[32:35], 0
    v_mfma_f32_16x16x32_bf16 v[68:71], v[148:151], v[36:39], v[68:71]
    v_mfma_f32_16x16x32_bf16 v[68:71], v[152:155], v[40:43], v[68:71]
    v_mfma_f32_16x16x32_bf16 v[68:71], v[156:159], v[44:47], v[68:71]
    s_cbranch_scc1 L_sk_13
    s_mov_b32 m0, s64
    s_waitcnt vmcnt(6)
    s_cbranch_vccnz L_tb_14
    s_waitcnt vmcnt(4)
L_tb_14:
    buffer_load_dwordx4 v16, s[36:39], s52 offen offset:0 nt lds
    s_waitcnt vmcnt(6)
    s_cbranch_vccnz L_tb_15
    s_waitcnt vmcnt(4)
L_tb_15:
    buffer_load_dwordx4 v17, s[36:39], s52 offen offset:1024 nt lds
    s_mov_b64 exec, 1
    ds_add_rtn_u32 v29, v27, v28 offset:24
    ds_read_b32 v31, v27 offset:16
    s_waitcnt lgkmcnt(0)
    v_add_u32 v29, v29, v31
    v_cmp_ge_i32 vcc, v29, v24
    v_add_u32 v24, 4, v24
    s_mov_b64 exec, -1
L_sk_13:
    s_nop 6
    v_cvt_pk_bf16_f32 v72, v64, v65
    v_max3_f32 v8, v8, v64, v65
    v_cvt_pk_bf16_f32 v73, v66, v67
    v_max3_f32 v8, v8, v66, v67
    v_cvt_pk_bf16_f32 v74, v68, v69
    v_max3_f32 v8, v8, v68, v69
    v_cvt_pk_bf16_f32 v75, v70, v71
    v_max3_f32 v8, v8, v70, v71
    v_lshlrev_b32 v64, 16, v72
    v_and_b32 v65, s60, v72
    v_mul_f32 v64, s48, v64
    v_mul_f32 v65, s48, v65
    v_cvt_pk_bf16_f32 v72, v64, v65
    v_lshlrev_b32 v66, 16, v73
    v_and_b32 v67, s60, v73
    v_mul_f32 v66, s48, v66
    v_mul_f32 v67, s48, v67
    v_cvt_pk_bf16_f32 v73, v66, v67
    v_lshlrev_b32 v68, 16, v74
    v_and_b32 v69, s60, v74
    v_mul_f32 v68, s48, v68
    v_mul_f32 v69, s48, v69
    v_cvt_pk_bf16_f32 v74, v68, v69
    v_lshlrev_b32 v70, 16, v75
    v_and_b32 v71, s60, v75
    v_mul_f32 v70, s48, v70
    v_mul_f32 v71, s48, v71
    v_cvt_pk_bf16_f32 v75, v70, v71
    ds_write_b128 v12, v[72:75]
    v_add_u32 v12, 256, v12
    s_cbranch_scc1 L_sk_16
    s_waitcnt vmcnt(6)
    s_cbranch_vccnz L_tb_17
    s_waitcnt vmcnt(4)
L_tb_17:
    buffer_load_dwordx4 v18, s[36:39], s52 offen offset:2048 nt lds
    s_waitcnt vmcnt(6)
    s_cbranch_vccnz L_tb_18
    s_waitcnt vmcnt(4)
L_tb_18:
    buffer_load_dwordx4 v19, s[36:39], s52 offen offset:3072 nt lds
    s_mov_b32 m0, s65
    s_waitcnt vmcnt(6)
    s_cbranch_vccnz L_tb_19
    s_waitcnt vmcnt(4)
L_tb_19:
    buffer_load_dwordx4 v16, s[36:39], s53 offen offset:0 nt lds
    s_waitcnt vmcnt(6)
    s_cbranch_vccnz L_tb_20
    s_waitcnt vmcnt(4)
L_tb_20:
    buffer_load_dwordx4 v17, s[36:39], s53 offen offset:1024 nt lds
    s_waitcnt vmcnt(6)
    s_cbranch_vccnz L_tb_21
    s_waitcnt vmcnt(4)
L_tb_21:
    buffer_load_dwordx4 v18, s[36:39], s53 offen offset:2048 nt lds
    s_waitcnt vmcnt(6)
    s_cbranch_vccnz L_tb_22
    s_waitcnt vmcnt(4)
L_tb_22:
    buffer_load_dwordx4 v19, s[36:39], s53 offen offset:3072 nt lds
L_sk_16:
    s_add_u32 s52, s52, s59
    s_add_u32 s53, s53, s59
    s_xor_b32 s59, s59, 0x10000
    s_add_u32 s64, s64, 8192
    s_cmp_eq_u32 s64, s67
    s_cselect_b32 s64, s66, s64
    s_add_u32 s65, s64, 4096
    s_add_u32 s62, s62, 1
    s_cmp_eq_u32 s62, 13
    s_cbranch_scc0 L_kn
    s_waitcnt vmcnt(6)
    s_cbranch_vccnz L_tb_23
    s_waitcnt vmcnt(4)
L_tb_23:
    buffer_load_dwordx4 v[192:195], v4, s[40:43], s54 offen offset:0 nt
    s_waitcnt vmcnt(6)
    s_cbranch_vccnz L_tb_24
    s_waitcnt vmcnt(4)
L_tb_24:
    buffer_load_dwordx4 v[196:199], v4, s[40:43], s54 offen offset:1024 nt
    s_mov_b64 exec, 1
    ds_add_rtn_u32 v29, v27, v28 offset:24
    ds_read_b32 v31, v27 offset:16
    s_waitcnt lgkmcnt(0)
    v_add_u32 v29, v29, v31
    v_cmp_ge_i32 vcc, v29, v24
    v_add_u32 v24, 4, v24
    s_mov_b64 exec, -1
    s_waitcnt vmcnt(6)
    s_cbranch_vccnz L_tb_25
    s_waitcnt vmcnt(4)
L_tb_25:
    buffer_load_dwordx4 v[200:203], v4, s[40:43], s54 offen offset:2048 nt
    s_waitcnt vmcnt(6)
    s_cbranch_vccnz L_tb_26
    s_waitcnt vmcnt(4)
L_tb_26:
    buffer_load_dwordx4 v[204:207], v4, s[40:43], s54 offen offset:3072 nt
    s_waitcnt vmcnt(6)
    s_cbranch_vccnz L_tb_27
    s_waitcnt vmcnt(4)
L_tb_27:
    buffer_load_dwordx4 v[208:211], v4, s[40:43], s55 offen offset:0 nt
    s_waitcnt vmcnt(6)
    s_cbranch_vccnz L_tb_28
    s_waitcnt vmcnt(4)
L_tb_28:
    buffer_load_dwordx4 v[212:215], v4, s[40:43], s55 offen offset:1024 nt
    s_waitcnt vmcnt(6)
    s_cbranch_vccnz L_tb_29
    s_waitcnt vmcnt(4)
L_tb_29:
    buffer_load_dwordx4 v[216:219], v4, s[40:43], s55 offen offset:2048 nt
    s_waitcnt vmcnt(6)
    s_cbranch_vccnz L_tb_30
    s_waitcnt vmcnt(4)
L_tb_30:
    buffer_load_dwordx4 v[220:223], v4, s[40:43], s55 offen offset:3072 nt
    s_add_u32 s54, s54, s61
    s_add_u32 s55, s55, s61
    s_xor_b32 s61, s61, 0x10000
    s_waitcnt vmcnt(11)
    buffer_load_dwordx4 v[224:227], v4, s[40:43], s54 offen offset:0 nt
    s_waitcnt vmcnt(11)
    buffer_load_dwordx4 v[228:231], v4, s[40:43], s54 offen offset:1024 nt
    s_waitcnt vmcnt(11)
    buffer_load_dwordx4 v[232:235], v4, s[40:43], s54 offen offset:2048 nt
    s_waitcnt vmcnt(11)
    buffer_load_dwordx4 v[236:239], v4, s[40:43], s54 offen offset:3072 nt
    s_waitcnt vmcnt(11)
    buffer_load_dwordx4 v[240:243], v4, s[40:43], s55 offen offset:0 nt
    s_waitcnt vmcnt(11)
    buffer_load_dwordx4 v[244:247], v4, s[40:43], s55 offen offset:1024 nt
    s_waitcnt vmcnt(11)
    buffer_load_dwordx4 v[248:251], v4, s[40:43], s55 offen offset:2048 nt
    s_waitcnt vmcnt(11)
    buffer_load_dwordx4 v[252:255], v4, s[40:43], s55 offen offset:3072 nt
    s_add_u32 s54, s54, s61
    s_add_u32 s55, s55, s61
    s_xor_b32 s61, s61, 0x10000
L_kn:
    s_cmp_lt_u32 s62, 16
    s_cbranch_scc1 L_k
    v_subrev_u32 v12, 4096, v12
    ds_read_b128 v[128:131], v12
    v_mov_b32 v13, v8
    s_nop 1
    v_permlane32_swap_b32 v8, v13
    v_max_f32 v8, v8, v13
    v_mov_b32 v13, v8
    s_nop 1
    v_permlane16_swap_b32 v8, v13
    v_max_f32 v8, v8, v13
    v_cvt_pk_bf16_f32 v9, v8, v8
    v_lshlrev_b32 v9, 16, v9
    v_mul_f32 v9, s48, v9
    v_cvt_pk_bf16_f32 v9, v9, v9
    v_lshlrev_b32 v9, 16, v9
    v_mul_f32 v9, s49, v9
    s_mov_b32 s62, 0
    s_waitcnt lgkmcnt(0)
    v_lshlrev_b32 v132, 16, v128
    v_and_b32 v133, s60, v128
    v_fma_f32 v132, v132, s49, -v9
    v_fma_f32 v133, v133, s49, -v9
    v_exp_f32 v132, v132
    v_exp_f32 v133, v133
    v_lshlrev_b32 v134, 16, v129
    v_and_b32 v135, s60, v129
    v_fma_f32 v134, v134, s49, -v9
    v_fma_f32 v135, v135, s49, -v9
    v_exp_f32 v134, v134
    v_exp_f32 v135, v135
    v_lshlrev_b32 v136, 16, v130
    v_and_b32 v137, s60, v130
    v_fma_f32 v136, v136, s49, -v9
    v_fma_f32 v137, v137, s49, -v9
    v_exp_f32 v136, v136
    v_exp_f32 v137, v137
    v_lshlrev_b32 v138, 16, v131
    v_and_b32 v139, s60, v131
    v_fma_f32 v138, v138, s49, -v9
    v_fma_f32 v139, v139, s49, -v9
    v_exp_f32 v138, v138
    v_exp_f32 v139, v139
    v_add_f32 v10, v10, v132
    v_add_f32 v11, v11, v133
    v_cvt_pk_bf16_f32 v48, v132, v133
    v_add_f32 v10, v10, v134
    v_add_f32 v11, v11, v135
    v_cvt_pk_bf16_f32 v49, v134, v135
    v_add_f32 v10, v10, v136
    v_add_f32 v11, v11, v137
    v_cvt_pk_bf16_f32 v50, v136, v137
    v_add_f32 v10, v10, v138
    v_add_f32 v11, v11, v139
    v_cvt_pk_bf16_f32 v51, v138, v139
.p2align 6
L_v:
    s_cmp_eq_u32 s62, 7
    s_waitcnt vmcnt(8)
    ds_read_b128 v[128:131], v12 offset:256
    v_perm_b32 v64, v196, v192, s50
    v_perm_b32 v68, v196, v192, s51
    v_perm_b32 v65, v204, v200, s50
    v_perm_b32 v69, v204, v200, s51
    v_perm_b32 v66, v212, v208, s50
    v_perm_b32 v70, v212, v208, s51
    v_perm_b32 v67, v220, v216, s50
    v_perm_b32 v71, v220, v216, s51
    v_perm_b32 v72, v197, v193, s50
    v_perm_b32 v76, v197, v193, s51
    v_perm_b32 v73, v205, v201, s50
    v_perm_b32 v77, v205, v201, s51
    v_perm_b32 v74, v213, v209, s50
    v_perm_b32 v78, v213, v209, s51
    v_perm_b32 v75, v221, v217, s50
    v_perm_b32 v79, v221, v217, s51
    v_mfma_f32_16x16x32_bf16 v[96:99], v[64:67], v[48:51], v[96:99]
    v_mfma_f32_16x16x32_bf16 v[100:103], v[68:71], v[48:51], v[100:103]
    v_perm_b32 v80, v198, v194, s50
    v_perm_b32 v84, v198, v194, s51
    v_perm_b32 v81, v206, v202, s50
    v_perm_b32 v85, v206, v202, s51
    v_perm_b32 v82, v214, v210, s50
    v_perm_b32 v86, v214, v210, s51
    v_perm_b32 v83, v222, v218, s50
    v_perm_b32 v87, v222, v218, s51
    v_mfma_f32_16x16x32_bf16 v[104:107], v[72:75], v[48:51], v[104:107]
    v_mfma_f32_16x16x32_bf16 v[108:111], v[76:79], v[48:51], v[108:111]
    v_perm_b32 v88, v199, v195, s50
    v_perm_b32 v92, v199, v195, s51
    v_perm_b32 v89, v207, v203, s50
    v_perm_b32 v93, v207, v203, s51
    v_perm_b32 v90, v215, v211, s50
    v_perm_b32 v94, v215, v211, s51
    v_perm_b32 v91, v223, v219, s50
    v_perm_b32 v95, v223, v219, s51
    v_mfma_f32_16x16x32_bf16 v[112:115], v[80:83], v[48:51], v[112:115]
    v_mfma_f32_16x16x32_bf16 v[116:119], v[84:87], v[48:51], v[116:119]
    s_nop 0
    v_mfma_f32_16x16x32_bf16 v[120:123], v[88:91], v[48:51], v[120:123]
    v_mfma_f32_16x16x32_bf16 v[124:127], v[92:95], v[48:51], v[124:127]
    s_cbranch_scc1 L_sk_31
    s_waitcnt vmcnt(6)
    s_cbranch_vccnz L_tb_32
    s_waitcnt vmcnt(4)
L_tb_32:
    buffer_load_dwordx4 v[192:195], v4, s[40:43], s54 offen offset:0 nt
    s_waitcnt vmcnt(6)
    s_cbranch_vccnz L_tb_33
    s_waitcnt vmcnt(4)
L_tb_33:
    buffer_load_dwordx4 v[196:199], v4, s[40:43], s54 offen offset:1024 nt
    s_mov_b64 exec, 1
    ds_add_rtn_u32 v29, v27, v28 offset:24
    ds_read_b32 v31, v27 offset:16
    s_waitcnt lgkmcnt(0)
    v_add_u32 v29, v29, v31
    v_cmp_ge_i32 vcc, v29, v24
    v_add_u32 v24, 4, v24
    s_mov_b64 exec, -1
L_sk_31:
    s_waitcnt lgkmcnt(0)
    v_lshlrev_b32 v132, 16, v128
    v_and_b32 v133, s60, v128
    v_fma_f32 v132, v132, s49, -v9
    v_fma_f32 v133, v133, s49, -v9
    v_exp_f32 v132, v132
    v_exp_f32 v133, v133
    v_lshlrev_b32 v134, 16, v129
    v_and_b32 v135, s60, v129
    v_fma_f32 v134, v134, s49, -v9
    v_fma_f32 v135, v135, s49, -v9
    v_exp_f32 v134, v134
    v_exp_f32 v135, v135
    v_lshlrev_b32 v136, 16, v130
    v_and_b32 v137, s60, v130
    v_fma_f32 v136, v136, s49, -v9
    v_fma_f32 v137, v137, s49, -v9
    v_exp_f32 v136, v136
    v_exp_f32 v137, v137
    v_lshlrev_b32 v138, 16, v131
    v_and_b32 v139, s60, v131
    v_fma_f32 v138, v138, s49, -v9
    v_fma_f32 v139, v139, s49, -v9
    v_exp_f32 v138, v138
    v_exp_f32 v139, v139
    s_cbranch_scc1 L_sk_34
    s_waitcnt vmcnt(6)
    s_cbranch_vccnz L_tb_35
    s_waitcnt vmcnt(4)
L_tb_35:
    buffer_load_dwordx4 v[200:203], v4, s[40:43], s54 offen offset:2048 nt
L_sk_34:
    v_add_f32 v10, v10, v132
    v_add_f32 v11, v11, v133
    v_cvt_pk_bf16_f32 v52, v132, v133
    v_add_f32 v10, v10, v134
    v_add_f32 v11, v11, v135
    v_cvt_pk_bf16_f32 v53, v134, v135
    v_add_f32 v10, v10, v136
    v_add_f32 v11, v11, v137
    v_cvt_pk_bf16_f32 v54, v136, v137
    v_add_f32 v10, v10, v138
    v_add_f32 v11, v11, v139
    v_cvt_pk_bf16_f32 v55, v138, v139
    s_cbranch_scc0 L_notlast
    v_add_f32 v10, v10, v11
    v_mov_b32 v13, v10
    s_nop 1
    v_permlane32_swap_b32 v10, v13
    v_add_f32 v10, v10, v13
    v_mov_b32 v13, v10
    s_nop 1
    v_permlane16_swap_b32 v10, v13
    v_add_f32 v10, v10, v13
    v_mov_b32 v8, v9
    v_mov_b32 v9, v10
    ds_write_b64 v15, v[8:9]
    s_waitcnt vmcnt(2)
    s_add_u32 m0, s63, 114688
    s_mov_b32 s36, s12
    s_and_b32 s37, s13, 0xffff
    s_mov_b32 s38, 0x400000
    s_lshl_b32 s56, s30, 2
    s_add_u32 s56, s56, s28
    s_lshl_b32 s56, s56, 15
    s_lshl_b32 s33, s29, 7
    s_add_u32 s56, s56, s33
    buffer_load_dwordx4 v26, s[36:39], s56 offen nt lds
    s_add_u32 m0, m0, 1024
    s_add_u32 s56, s56, 8192
    v_xor_b32 v30, 32, v26
    buffer_load_dwordx4 v30, s[36:39], s56 offen nt lds
    s_add_u32 m0, m0, 1024
    s_add_u32 s56, s56, 8192
    v_xor_b32 v30, 64, v26
    buffer_load_dwordx4 v30, s[36:39], s56 offen nt lds
    s_add_u32 m0, m0, 1024
    s_add_u32 s56, s56, 8192
    v_xor_b32 v30, 96, v26
    buffer_load_dwordx4 v30, s[36:39], s56 offen nt lds
    s_cmp_eq_u32 s62, 7
    s_waitcnt vmcnt(4)
    s_branch L_pv1
L_notlast:
    s_waitcnt vmcnt(6)
    s_cbranch_vccnz L_tb_36
    s_waitcnt vmcnt(4)
L_tb_36:
    buffer_load_dwordx4 v[204:207], v4, s[40:43], s54 offen offset:3072 nt
    s_waitcnt vmcnt(6)
    s_cbranch_vccnz L_tb_37
    s_waitcnt vmcnt(4)
L_tb_37:
    buffer_load_dwordx4 v[208:211], v4, s[40:43], s55 offen offset:0 nt
    s_waitcnt vmcnt(6)
    s_cbranch_vccnz L_tb_38
    s_waitcnt vmcnt(4)
L_tb_38:
    buffer_load_dwordx4 v[212:215], v4, s[40:43], s55 offen offset:1024 nt
    s_waitcnt vmcnt(6)
    s_cbranch_vccnz L_tb_39
    s_waitcnt vmcnt(4)
L_tb_39:
    buffer_load_dwordx4 v[216:219], v4, s[40:43], s55 offen offset:2048 nt
    s_waitcnt vmcnt(6)
    s_cbranch_vccnz L_tb_40
    s_waitcnt vmcnt(4)
L_tb_40:
    buffer_load_dwordx4 v[220:223], v4, s[40:43], s55 offen offset:3072 nt
    s_add_u32 s54, s54, s61
    s_add_u32 s55, s55, s61
    s_xor_b32 s61, s61, 0x10000
    s_cmp_eq_u32 s62, 7
    s_waitcnt vmcnt(8)
L_pv1:
    ds_read_b128 v[128:131], v12 offset:512
    v_perm_b32 v64, v228, v224, s50
    v_perm_b32 v68, v228, v224, s51
    v_perm_b32 v65, v236, v232, s50
    v_perm_b32 v69, v236, v232, s51
    v_perm_b32 v66, v244, v240, s50
    v_perm_b32 v70, v244, v240, s51
    v_perm_b32 v67, v252, v248, s50
    v_perm_b32 v71, v252, v248, s51
    v_perm_b32 v72, v229, v225, s50
    v_perm_b32 v76, v229, v225, s51
    v_perm_b32 v73, v237, v233, s50
    v_perm_b32 v77, v237, v233, s51
    v_perm_b32 v74, v245, v241, s50
    v_perm_b32 v78, v245, v241, s51
    v_perm_b32 v75, v253, v249, s50
    v_perm_b32 v79, v253, v249, s51
    v_mfma_f32_16x16x32_bf16 v[96:99], v[64:67], v[52:55], v[96:99]
    v_mfma_f32_16x16x32_bf16 v[100:103], v[68:71], v[52:55], v[100:103]
    v_perm_b32 v80, v230, v226, s50
    v_perm_b32 v84, v230, v226, s51
    v_perm_b32 v81, v238, v234, s50
    v_perm_b32 v85, v238, v234, s51
    v_perm_b32 v82, v246, v242, s50
    v_perm_b32 v86, v246, v242, s51
    v_perm_b32 v83, v254, v250, s50
    v_perm_b32 v87, v254, v250, s51
    v_mfma_f32_16x16x32_bf16 v[104:107], v[72:75], v[52:55], v[104:107]
    v_mfma_f32_16x16x32_bf16 v[108:111], v[76:79], v[52:55], v[108:111]
    v_perm_b32 v88, v231, v227, s50
    v_perm_b32 v92, v231, v227, s51
    v_perm_b32 v89, v239, v235, s50
    v_perm_b32 v93, v239, v235, s51
    v_perm_b32 v90, v247, v243, s50
    v_perm_b32 v94, v247, v243, s51
    v_perm_b32 v91, v255, v251, s50
    v_perm_b32 v95, v255, v251, s51
    v_mfma_f32_16x16x32_bf16 v[112:115], v[80:83], v[52:55], v[112:115]
    v_mfma_f32_16x16x32_bf16 v[116:119], v[84:87], v[52:55], v[116:119]
    s_nop 0
    v_mfma_f32_16x16x32_bf16 v[120:123], v[88:91], v[52:55], v[120:123]
    v_mfma_f32_16x16x32_bf16 v[124:127], v[92:95], v[52:55], v[124:127]
    s_cbranch_scc1 L_sdone
    s_cbranch_scc1 L_sk_41
    s_waitcnt vmcnt(6)
    s_cbranch_vccnz L_tb_42
    s_waitcnt vmcnt(4)
L_tb_42:
    buffer_load_dwordx4 v[224:227], v4, s[40:43], s54 offen offset:0 nt
    s_waitcnt vmcnt(6)
    s_cbranch_vccnz L_tb_43
    s_waitcnt vmcnt(4)
L_tb_43:
    buffer_load_dwordx4 v[228:231], v4, s[40:43], s54 offen offset:1024 nt
    s_mov_b64 exec, 1
    ds_add_rtn_u32 v29, v27, v28 offset:24
    ds_read_b32 v31, v27 offset:16
    s_waitcnt lgkmcnt(0)
    v_add_u32 v29, v29, v31
    v_cmp_ge_i32 vcc, v29, v24
    v_add_u32 v24, 4, v24
    s_mov_b64 exec, -1
L_sk_41:
    s_waitcnt lgkmcnt(0)
    v_lshlrev_b32 v132, 16, v128
    v_and_b32 v133, s60, v128
    v_fma_f32 v132, v132, s49, -v9
    v_fma_f32 v133, v133, s49, -v9
    v_exp_f32 v132, v132
    v_exp_f32 v133, v133
    v_lshlrev_b32 v134, 16, v129
    v_and_b32 v135, s60, v129
    v_fma_f32 v134, v134, s49, -v9
    v_fma_f32 v135, v135, s49, -v9
    v_exp_f32 v134, v134
    v_exp_f32 v135, v135
    v_lshlrev_b32 v136, 16, v130
    v_and_b32 v137, s60, v130
    v_fma_f32 v136, v136, s49, -v9
    v_fma_f32 v137, v137, s49, -v9
    v_exp_f32 v136, v136
    v_exp_f32 v137, v137
    v_lshlrev_b32 v138, 16, v131
    v_and_b32 v139, s60, v131
    v_fma_f32 v138, v138, s49, -v9
    v_fma_f32 v139, v139, s49, -v9
    v_exp_f32 v138, v138
    v_exp_f32 v139, v139
    s_cbranch_scc1 L_sk_44
    s_waitcnt vmcnt(6)
    s_cbranch_vccnz L_tb_45
    s_waitcnt vmcnt(4)
L_tb_45:
    buffer_load_dwordx4 v[232:235], v4, s[40:43], s54 offen offset:2048 nt
L_sk_44:
    v_add_f32 v10, v10, v132
    v_add_f32 v11, v11, v133
    v_cvt_pk_bf16_f32 v48, v132, v133
    v_add_f32 v10, v10, v134
    v_add_f32 v11, v11, v135
    v_cvt_pk_bf16_f32 v49, v134, v135
    v_add_f32 v10, v10, v136
    v_add_f32 v11, v11, v137
    v_cvt_pk_bf16_f32 v50, v136, v137
    v_add_f32 v10, v10, v138
    v_add_f32 v11, v11, v139
    v_cvt_pk_bf16_f32 v51, v138, v139
    s_waitcnt vmcnt(6)
    s_cbranch_vccnz L_tb_46
    s_waitcnt vmcnt(4)
L_tb_46:
    buffer_load_dwordx4 v[236:239], v4, s[40:43], s54 offen offset:3072 nt
    s_waitcnt vmcnt(6)
    s_cbranch_vccnz L_tb_47
    s_waitcnt vmcnt(4)
L_tb_47:
    buffer_load_dwordx4 v[240:243], v4, s[40:43], s55 offen offset:0 nt
    s_waitcnt vmcnt(6)
    s_cbranch_vccnz L_tb_48
    s_waitcnt vmcnt(4)
L_tb_48:
    buffer_load_dwordx4 v[244:247], v4, s[40:43], s55 offen offset:1024 nt
    s_waitcnt vmcnt(6)
    s_cbranch_vccnz L_tb_49
    s_waitcnt vmcnt(4)
L_tb_49:
    buffer_load_dwordx4 v[248:251], v4, s[40:43], s55 offen offset:2048 nt
    s_waitcnt vmcnt(6)
    s_cbranch_vccnz L_tb_50
    s_waitcnt vmcnt(4)
L_tb_50:
    buffer_load_dwordx4 v[252:255], v4, s[40:43], s55 offen offset:3072 nt
    s_add_u32 s54, s54, s61
    s_add_u32 s55, s55, s61
    s_xor_b32 s61, s61, 0x10000
    v_add_u32 v12, 512, v12
    s_add_u32 s62, s62, 1
    s_cmp_eq_u32 s62, 7
    s_cbranch_scc0 L_v
    s_branch L_v
L_sdone:
    v_mov_b32_dpp v96, v104 quad_perm:[0,1,2,3] row_mask:0xf bank_mask:0x2
    v_mov_b32_dpp v97, v105 quad_perm:[0,1,2,3] row_mask:0xf bank_mask:0x2
    v_mov_b32_dpp v98, v106 quad_perm:[0,1,2,3] row_mask:0xf bank_mask:0x2
    v_mov_b32_dpp v99, v107 quad_perm:[0,1,2,3] row_mask:0xf bank_mask:0x2
    v_mov_b32_dpp v100, v108 quad_perm:[0,1,2,3] row_mask:0xf bank_mask:0x2
    v_mov_b32_dpp v101, v109 quad_perm:[0,1,2,3] row_mask:0xf bank_mask:0x2
    v_mov_b32_dpp v102, v110 quad_perm:[0,1,2,3] row_mask:0xf bank_mask:0x2
    v_mov_b32_dpp v103, v111 quad_perm:[0,1,2,3] row_mask:0xf bank_mask:0x2
    v_mov_b32_dpp v96, v112 quad_perm:[0,1,2,3] row_mask:0xf bank_mask:0x4
    v_mov_b32_dpp v97, v113 quad_perm:[0,1,2,3] row_mask:0xf bank_mask:0x4
    v_mov_b32_dpp v98, v114 quad_perm:[0,1,2,3] row_mask:0xf bank_mask:0x4
    v_mov_b32_dpp v99, v115 quad_perm:[0,1,2,3] row_mask:0xf bank_mask:0x4
    v_mov_b32_dpp v100, v116 quad_perm:[0,1,2,3] row_mask:0xf bank_mask:0x4
    v_mov_b32_dpp v101, v117 quad_perm:[0,1,2,3] row_mask:0xf bank_mask:0x4
    v_mov_b32_dpp v102, v118 quad_perm:[0,1,2,3] row_mask:0xf bank_mask:0x4
    v_mov_b32_dpp v103, v119 quad_perm:[0,1,2,3] row_mask:0xf bank_mask:0x4
    v_mov_b32_dpp v96, v120 quad_perm:[0,1,2,3] row_mask:0xf bank_mask:0x8
    v_mov_b32_dpp v97, v121 quad_perm:[0,1,2,3] row_mask:0xf bank_mask:0x8
    v_mov_b32_dpp v98, v122 quad_perm:[0,1,2,3] row_mask:0xf bank_mask:0x8
    v_mov_b32_dpp v99, v123 quad_perm:[0,1,2,3] row_mask:0xf bank_mask:0x8
    v_mov_b32_dpp v100, v124 quad_perm:[0,1,2,3] row_mask:0xf bank_mask:0x8
    v_mov_b32_dpp v101, v125 quad_perm:[0,1,2,3] row_mask:0xf bank_mask:0x8
    v_mov_b32_dpp v102, v126 quad_perm:[0,1,2,3] row_mask:0xf bank_mask:0x8
    v_mov_b32_dpp v103, v127 quad_perm:[0,1,2,3] row_mask:0xf bank_mask:0x8
    ds_write_b128 v14, v[96:99]
    ds_write_b128 v14, v[100:103] offset:256
    s_waitcnt lgkmcnt(0)
    s_barrier
    s_waitcnt vmcnt(0)
    s_barrier
L_exit:
L_end:
    s_endpgm
.section .rodata,"a"
.p2align 6
.amdhsa_kernel parallel_sum__gqa_block_cached__glu_gated_bilinear__decode_kernel
  .amdhsa_next_free_vgpr 256
  .amdhsa_next_free_sgpr 96
  .amdhsa_accum_offset 256
  .amdhsa_group_segment_fixed_size 0
  .amdhsa_kernarg_size 96
  .amdhsa_user_sgpr_count 2
  .amdhsa_user_sgpr_kernarg_segment_ptr 1
  .amdhsa_system_sgpr_workgroup_id_x 1
.end_amdhsa_kernel
```
